```python
import torch

def _softmax(x, axis=-1):
    return torch.softmax(x, dim=axis)
def _gelu(x):
    return torch.nn.functional.gelu(x, approximate="tanh")
def _silu(x):
    return torch.nn.functional.silu(x)
def _sigmoid(x):
    return torch.sigmoid(x)
def _layernorm(x, axis=-1, eps=1e-5):
    m = x.mean(dim=axis, keepdim=True)
    v = x.var(dim=axis, keepdim=True, unbiased=False)
    return (x - m) / torch.sqrt(v + eps)
def _scatter_add(tgt, idx, src, axis=0):
    return tgt.clone().index_add_(axis, idx, src)
def _segment_sum(src, seg, n):
    out = torch.zeros((n,) + src.shape[1:], dtype=src.dtype)
    return out.index_add_(0, seg, src)
def _pad(x, pw):
    flat = tuple(v for pair in reversed(pw) for v in pair)
    return torch.nn.functional.pad(x, flat)

kernel_name = 'concat_heads__sliding_block__spectral_fnet__prompt'

def setup_inputs():

    _w = (lambda a: (lambda t: t.to(torch.bfloat16) if t.is_floating_point() else t)(torch.as_tensor(a)))
    def _A_setup():
        B, S, D = 1, 2048, 1024
        return {
            "x": _w((lambda *s: torch.randn(*s, dtype=torch.bfloat16) * 0.2)(B, S, D)),
            "wqkv": _w((lambda *s: torch.randn(*s, dtype=torch.bfloat16) * 0.8)(D, 3 * D)),
            "wo": _w((lambda *s: torch.randn(*s, dtype=torch.bfloat16) * 0.2)(D, D)),
        }
    _A_in = _A_setup()

    def _B_setup():
        B, S, D = 1, 2048, 1024
        ns = torch.arange(S)[:, None] * torch.arange(S)[None, :]
        nd = torch.arange(D)[:, None] * torch.arange(D)[None, :]
        Ws_re = torch.cos(-2.0 * torch.pi * ns / S).to(float)
        Ws_im = torch.sin(-2.0 * torch.pi * ns / S).to(float)
        Wd_re = torch.cos(-2.0 * torch.pi * nd / D).to(float)
        Wd_im = torch.sin(-2.0 * torch.pi * nd / D).to(float)
        return {
            "x": _w((lambda *s: torch.randn(*s, dtype=torch.bfloat16) * 0.05)(B, S, D)),
            "dft_seq_re": _w(Ws_re),
            "dft_seq_im": _w(Ws_im),
            "dft_hid_re": _w(Wd_re),
            "dft_hid_im": _w(Wd_im),
        }
    _B_in = _B_setup()

    return {
        "A_x": _A_in["x"],
        "A_wqkv": _A_in["wqkv"],
        "A_wo": _A_in["wo"],
        "B_x": _B_in["x"],
        "B_dft_seq_re": _B_in["dft_seq_re"],
        "B_dft_seq_im": _B_in["dft_seq_im"],
        "B_dft_hid_re": _B_in["dft_hid_re"],
        "B_dft_hid_im": _B_in["dft_hid_im"],
    }

def reference(A_x, A_wqkv, A_wo, B_x, B_dft_seq_re, B_dft_seq_im, B_dft_hid_re, B_dft_hid_im):
    def _A_ref(x, wqkv, wo):
        B, S, D = x.shape
        H = 32; Dh = D // H; W = 256
        qkv = (lambda x, *d: x.permute(*d))((x @ wqkv).reshape(B, S, 3, H, Dh), 2, 0, 3, 1, 4)
        q, k, v = qkv[0], qkv[1], qkv[2]
        scores = torch.einsum("bhqd,bhkd->bhqk", q, k) * (Dh ** -0.5)
        idx = torch.arange(S)
        mask = (idx[:, None] - idx[None, :] >= 0) & (idx[:, None] - idx[None, :] < W)
        scores = torch.where(mask[None, None], scores, -1e9)
        p = _softmax(scores, axis=-1)
        o = torch.einsum("bhqk,bhkd->bhqd", p, v)
        return (lambda x, *d: x.permute(*d))(o, 0, 2, 1, 3).reshape(B, S, D) @ wo

    def _B_ref(x, dft_seq_re, dft_seq_im, dft_hid_re, dft_hid_im):
        a = torch.einsum("bsd,ed->bse", x, dft_hid_re)
        b = torch.einsum("bsd,ed->bse", x, dft_hid_im)
        y = torch.einsum("ts,bse->bte", dft_seq_re, a) - torch.einsum("ts,bse->bte", dft_seq_im, b)
        return y

    a = _A_ref(A_x, A_wqkv, A_wo)
    b = _B_ref(B_x, B_dft_seq_re, B_dft_seq_im, B_dft_hid_re, B_dft_hid_im)
    return torch.concatenate([a, b], axis=-1)
```

```asm
; @launch grid=(256,1,1) block=(512,1,1) lds=163840
.amdgcn_target "amdgcn-amd-amdhsa--gfx950"
.text
.globl concat_heads__sliding_block__spectral_fnet__prompt_kernel
.p2align 8
.type concat_heads__sliding_block__spectral_fnet__prompt_kernel,@function
concat_heads__sliding_block__spectral_fnet__prompt_kernel:
    s_load_dwordx8 s[40:47], s[0:1], 0
    s_load_dwordx4 s[48:51], s[0:1], 64
    s_load_dwordx2 s[52:53], s[0:1], 80
    v_lshrrev_b32 v3, 6, v0
    s_cmp_ge_u32 s2, 256
    v_and_b32 v1, 63, v0
    v_readfirstlane_b32 s32, v3
    s_cbranch_scc1 L_end
    s_getpc_b64 s[36:37]
L_pcbase:
    s_and_b32 s38, s2, 0xf8
    v_add_lshl_u32 v3, v3, s38, 7
    v_min_u32 v3, L_codeend-L_pcbase-4, v3
    global_load_dword v0, v3, s[36:37]
    s_bfe_u32 s33, s2, 0x30003
    s_lshl_b32 s38, s2, 1
    s_and_b32 s38, s38, 8
    s_add_u32 s33, s33, s38
    s_and_b32 s34, s2, 3
    s_lshl_b32 s34, s34, 2
    s_lshr_b32 s38, s2, 6
    s_add_u32 s34, s34, s38
    v_lshrrev_b32 v8, 3, v1
    v_and_b32 v9, 7, v1
    v_lshrrev_b32 v10, 1, v8
    v_lshlrev_b32 v2, 4, v1
    s_mov_b32 s39, 40960
    s_cmp_lt_u32 s32, 4
    s_cbranch_scc1 L_cons
L_prod:
    s_lshl_b32 s36, s32, 1
    s_and_b32 s37, s36, 4
    v_or_b32 v11, s37, v10
    v_xor_b32 v11, v11, v9
    v_lshlrev_b32 v11, 4, v11
    v_lshl_add_u32 v4, v8, 11, v11
    v_and_b32 v11, 1, v10
    s_and_b32 s37, s36, 2
    v_or_b32 v11, s37, v11
    v_lshlrev_b32 v11, 1, v11
    v_xor_b32 v11, v11, v9
    v_lshlrev_b32 v11, 4, v11
    v_mul_u32_u24 v12, 6144, v8
    v_add_u32 v5, v11, v12
    s_sub_u32 s54, s32, 4
    s_lshl_b32 s55, s33, 18
    s_lshl_b32 s36, s54, 14
    s_add_u32 s55, s55, s36
    s_mul_i32 s56, s54, 49152
    s_lshl_b32 s36, s34, 7
    s_add_u32 s56, s56, s36
    s_lshl_b32 s57, s54, 10
    s_mov_b32 s58, 0
    s_and_b32 s36, s33, 7
    s_and_b32 s37, s34, 3
    s_add_u32 s37, s37, s36
    s_lshl_b32 s37, s37, 2
    s_mov_b32 s60, 3359688768
    s_mov_b32 s61, 2112
    s_lshr_b64 s[60:61], s[60:61], s37
    s_lshl_b32 s36, s36, 1
    s_and_b32 s37, s34, 7
    s_cmp_eq_u32 s37, 3
    s_cselect_b32 s59, s36, s60
    s_and_b32 s59, s59, 15
    s_mov_b32 s6, 4194304
    s_mov_b32 s7, 0x20000
    s_mov_b32 s10, 6291456
    s_mov_b32 s11, 0x20000
    s_waitcnt lgkmcnt(0)
    s_mov_b64 s[4:5], s[40:41]
    s_mov_b64 s[8:9], s[42:43]
    s_mov_b64 s[16:17], s[44:45]
    s_mov_b64 s[20:21], s[46:47]
    s_mov_b64 s[24:25], s[48:49]
    s_mov_b64 s[28:29], s[50:51]
    s_mov_b64 s[12:13], s[52:53]
    s_mov_b64 s[40:41], s[54:55]
    s_mov_b64 s[42:43], s[56:57]
    s_mov_b64 s[44:45], s[58:59]
    s_getpc_b64 s[50:51]
L_pc3:
    s_add_u32 s50, s50, L_ret0-L_pc3
    s_addc_u32 s51, s51, 0
L_issue:
    s_lshl_b32 s46, s45, 7
    s_add_u32 s46, s46, s41
    s_mul_i32 s47, s45, 393216
    s_add_u32 s47, s47, s42
    s_add_u32 m0, s43, 0
    s_add_u32 s48, s46, 0
    buffer_load_dwordx4 v4, s[4:7], s48 offen lds
    s_add_u32 m0, s43, 4096
    s_add_u32 s48, s46, 65536
    buffer_load_dwordx4 v4, s[4:7], s48 offen lds
    s_add_u32 m0, s43, 8192
    s_add_u32 s48, s46, 131072
    buffer_load_dwordx4 v4, s[4:7], s48 offen lds
    s_add_u32 m0, s43, 12288
    s_add_u32 s48, s46, 196608
    buffer_load_dwordx4 v4, s[4:7], s48 offen lds
    s_add_u32 m0, s43, 16384
    s_add_u32 s48, s47, 0
    buffer_load_dwordx4 v5, s[8:11], s48 offen lds
    s_add_u32 m0, s43, 20480
    s_add_u32 s48, s47, 196608
    buffer_load_dwordx4 v5, s[8:11], s48 offen lds
    s_add_u32 m0, s43, 24576
    s_add_u32 s48, s47, 2048
    buffer_load_dwordx4 v5, s[8:11], s48 offen lds
    s_add_u32 m0, s43, 28672
    s_add_u32 s48, s47, 198656
    buffer_load_dwordx4 v5, s[8:11], s48 offen lds
    s_add_u32 m0, s43, 32768
    s_add_u32 s48, s47, 4096
    buffer_load_dwordx4 v5, s[8:11], s48 offen lds
    s_add_u32 m0, s43, 36864
    s_add_u32 s48, s47, 200704
    buffer_load_dwordx4 v5, s[8:11], s48 offen lds
    s_add_u32 s45, s45, 1
    s_and_b32 s45, s45, 15
    s_add_u32 s44, s44, 1
    s_cmp_eq_u32 s44, 3
    s_cselect_b32 s48, 4294885376, s39
    s_cselect_b32 s44, 0, s44
    s_add_u32 s43, s43, s48
    s_setpc_b64 s[50:51]
L_ret0:
    s_mov_b32 s18, 2097152
    s_mov_b32 s19, 0x20000
    s_mov_b32 s22, 4194304
    s_mov_b32 s23, 0x20000
    s_mov_b32 s26, 8388608
    s_mov_b32 s27, 0x20000
    s_mov_b32 s30, 256
    s_mov_b32 s31, 0x20000
    s_mov_b32 s14, 268435456
    s_mov_b32 s15, 0x20000
    v_mov_b32 v46, -1
    v_mov_b32 v47, -1
    v_and_b32 v12, 31, v1
    v_cvt_f32_u32 v12, v12
    s_cmp_lt_u32 s40, 2
    s_cselect_b32 s36, 1023410176, 0
    s_cselect_b32 s37, 0, 981467136
    s_or_b32 s36, s36, s37
    s_and_b32 s37, s40, 1
    s_cselect_b32 s37, 1048576000, 0
    v_mul_f32 v12, s36, v12
    v_lshrrev_b32 v13, 5, v1
    v_cvt_f32_u32 v13, v13
    v_mul_f32 v13, 4.0, v13
    v_fma_f32 v16, v12, v13, s37
    v_mul_f32 v10, 0x40a00000, v12
    v_add_f32 v17, v16, v12
    v_add_f32 v18, v17, v12
    v_add_f32 v19, v18, v12
    v_add_f32 v20, v19, v10
    v_add_f32 v21, v20, v12
    v_add_f32 v22, v21, v12
    v_add_f32 v23, v22, v12
    v_add_f32 v24, v23, v10
    v_add_f32 v25, v24, v12
    v_add_f32 v26, v25, v12
    v_add_f32 v27, v26, v12
    v_add_f32 v28, v27, v10
    v_add_f32 v29, v28, v12
    v_add_f32 v30, v29, v12
    v_add_f32 v31, v30, v12
    v_cos_f32 v16, v16
    v_cos_f32 v17, v17
    v_cos_f32 v18, v18
    v_cos_f32 v19, v19
    v_cos_f32 v20, v20
    v_cos_f32 v21, v21
    v_cos_f32 v22, v22
    v_cos_f32 v23, v23
    v_cos_f32 v24, v24
    v_cos_f32 v25, v25
    v_cos_f32 v26, v26
    v_cos_f32 v27, v27
    v_cos_f32 v28, v28
    v_cos_f32 v29, v29
    v_cos_f32 v30, v30
    v_cos_f32 v31, v31
    s_cmp_lt_u32 s40, 2
    s_cbranch_scc0 L_cw23
    v_cvt_pk_bf16_f32 v32, v16, v17
    v_cvt_pk_bf16_f32 v33, v18, v19
    v_cvt_pk_bf16_f32 v34, v20, v21
    v_cvt_pk_bf16_f32 v35, v22, v23
    v_cvt_pk_bf16_f32 v36, v24, v25
    v_cvt_pk_bf16_f32 v37, v26, v27
    v_cvt_pk_bf16_f32 v38, v28, v29
    v_cvt_pk_bf16_f32 v39, v30, v31
    s_lshl_b32 s36, s40, 11
    s_add_u32 s36, s36, 149504
    v_add_u32 v12, s36, v2
    ds_write_b128 v12, v[32:35]
    ds_write_b128 v12, v[36:39] offset:1024
    s_cmp_eq_u32 s40, 0
    s_cbranch_scc1 L_cwdone
    v_xor_b32 v40, 0x80008000, v32
    v_xor_b32 v41, 0x80008000, v33
    v_xor_b32 v42, 0x80008000, v34
    v_xor_b32 v43, 0x80008000, v35
    v_xor_b32 v44, 0x80008000, v36
    v_xor_b32 v45, 0x80008000, v37
    v_xor_b32 v46, 0x80008000, v38
    v_xor_b32 v47, 0x80008000, v39
    ds_write_b128 v12, v[40:43] offset:2048
    ds_write_b128 v12, v[44:47] offset:3072
    s_branch L_cwdone
L_cw23:
    s_lshl_b32 s36, s40, 12
    s_add_u32 s36, s36, 147456
    v_add_u32 v12, s36, v2
    ds_write_b128 v12, v[16:19]
    ds_write_b128 v12, v[20:23] offset:1024
    ds_write_b128 v12, v[24:27] offset:2048
    ds_write_b128 v12, v[28:31] offset:3072
L_cwdone:
    v_add_u32 v3, 139264, v2
    s_cmp_eq_u32 s40, 0
    s_cbranch_scc1 L_tab_addr
    s_cmp_eq_u32 s40, 2
    s_cbranch_scc1 L_tab_mask
    s_cmp_eq_u32 s40, 1
    s_cbranch_scc1 L_tab_done
    s_and_b32 s36, s2, 7
    s_lshl_b32 s36, s36, 3
    s_lshr_b32 s37, s2, 5
    s_add_u32 s36, s36, s37
    s_lshr_b32 s37, s2, 3
    s_and_b32 s38, s37, 1
    s_bfe_u32 s37, s37, 0x10001
    s_sub_u32 s49, 128, s36
    s_cmp_eq_u32 s36, 0
    s_cselect_b32 s49, 64, s49
    s_cmp_eq_u32 s37, 0
    s_cselect_b32 s49, s36, s49
    s_cselect_b32 s52, 3196059648, 0
    s_cselect_b32 s53, 0, 1048576000
    s_or_b32 s52, s52, s53
    s_cmp_eq_u32 s49, 64
    s_cselect_b32 s52, 0, s52
    s_cselect_b32 s36, 0, 1.0
    s_cmp_eq_u32 s49, 0
    s_cselect_b32 s37, 0, 1.0
    s_lshl_b32 s38, s38, 10
    s_add_u32 s49, s49, s38
    v_bfe_u32 v13, v1, 1, 3
    v_lshlrev_b32 v13, 7, v13
    v_add_u32 v13, s49, v13
    v_cvt_f32_u32 v13, v13
    v_mul_f32 v13, 973078528, v13
    v_and_b32 v10, 1, v1
    v_cvt_f32_u32 v10, v10
    v_mul_f32 v10, 1048576000, v10
    v_lshrrev_b32 v11, 4, v1
    v_lshlrev_b32 v11, 2, v11
    v_cvt_f32_u32 v11, v11
    v_fma_f32 v48, v13, v11, v10
    v_add_f32 v50, v48, v13
    v_add_f32 v52, v50, v13
    v_add_f32 v54, v52, v13
    v_add_f32 v49, s52, v48
    v_add_f32 v51, s52, v50
    v_add_f32 v53, s52, v52
    v_add_f32 v55, s52, v54
    v_cos_f32 v48, v48
    v_cos_f32 v49, v49
    v_cos_f32 v50, v50
    v_cos_f32 v51, v51
    v_cos_f32 v52, v52
    v_cos_f32 v53, v53
    v_cos_f32 v54, v54
    v_cos_f32 v55, v55
    v_mul_f32 v48, s36, v48
    v_mul_f32 v49, s37, v49
    v_mul_f32 v50, s36, v50
    v_mul_f32 v51, s37, v51
    v_mul_f32 v52, s36, v52
    v_mul_f32 v53, s37, v53
    v_mul_f32 v54, s36, v54
    v_mul_f32 v55, s37, v55
    v_cvt_pk_bf16_f32 v92, v48, v49
    v_cvt_pk_bf16_f32 v93, v50, v51
    v_cvt_pk_bf16_f32 v94, v52, v53
    v_cvt_pk_bf16_f32 v95, v54, v55
    ds_write_b128 v3, v[92:95] offset:8192
    s_branch L_tab_done
L_tab_mask:
    v_and_b32 v10, 31, v1
    v_lshrrev_b32 v11, 5, v1
    v_lshlrev_b32 v12, 2, v11
    v_sub_u32 v10, v12, v10
    v_cvt_f32_i32 v10, v10
    s_mov_b32 s36, 4048155338
    s_mov_b32 s37, s36
    s_mov_b32 s38, 0x0b0b0909
    v_add_f32 v32, 0, v10
    v_add_f32 v33, 1.0, v32
    v_add_f32 v34, 1.0, v33
    v_add_f32 v35, 1.0, v34
    v_add_f32 v36, 0x40a00000, v35
    v_add_f32 v37, 1.0, v36
    v_add_f32 v38, 1.0, v37
    v_add_f32 v39, 1.0, v38
    v_add_f32 v40, 0x40a00000, v39
    v_add_f32 v41, 1.0, v40
    v_add_f32 v42, 1.0, v41
    v_add_f32 v43, 1.0, v42
    v_add_f32 v44, 0x40a00000, v43
    v_add_f32 v45, 1.0, v44
    v_add_f32 v46, 1.0, v45
    v_add_f32 v47, 1.0, v46
    v_max_f32_e64 v192, v32, v32 clamp
    v_max_f32_e64 v193, v33, v33 clamp
    v_max_f32_e64 v194, v34, v34 clamp
    v_max_f32_e64 v195, v35, v35 clamp
    v_max_f32_e64 v196, v36, v36 clamp
    v_max_f32_e64 v197, v37, v37 clamp
    v_max_f32_e64 v198, v38, v38 clamp
    v_max_f32_e64 v199, v39, v39 clamp
    v_max_f32_e64 v200, v40, v40 clamp
    v_max_f32_e64 v201, v41, v41 clamp
    v_max_f32_e64 v202, v42, v42 clamp
    v_max_f32_e64 v203, v43, v43 clamp
    v_max_f32_e64 v204, v44, v44 clamp
    v_max_f32_e64 v205, v45, v45 clamp
    v_max_f32_e64 v206, v46, v46 clamp
    v_max_f32_e64 v207, v47, v47 clamp
    v_pk_mul_f32 v[192:193], v[192:193], s[36:37]
    v_pk_mul_f32 v[194:195], v[194:195], s[36:37]
    v_pk_mul_f32 v[196:197], v[196:197], s[36:37]
    v_pk_mul_f32 v[198:199], v[198:199], s[36:37]
    v_pk_mul_f32 v[200:201], v[200:201], s[36:37]
    v_pk_mul_f32 v[202:203], v[202:203], s[36:37]
    v_pk_mul_f32 v[204:205], v[204:205], s[36:37]
    v_pk_mul_f32 v[206:207], v[206:207], s[36:37]
    v_pk_add_f32 v[96:97], s[36:37], v[192:193] neg_lo:[0,1] neg_hi:[0,1]
    v_pk_add_f32 v[98:99], s[36:37], v[194:195] neg_lo:[0,1] neg_hi:[0,1]
    v_pk_add_f32 v[100:101], s[36:37], v[196:197] neg_lo:[0,1] neg_hi:[0,1]
    v_pk_add_f32 v[102:103], s[36:37], v[198:199] neg_lo:[0,1] neg_hi:[0,1]
    v_pk_add_f32 v[104:105], s[36:37], v[200:201] neg_lo:[0,1] neg_hi:[0,1]
    v_pk_add_f32 v[106:107], s[36:37], v[202:203] neg_lo:[0,1] neg_hi:[0,1]
    v_pk_add_f32 v[108:109], s[36:37], v[204:205] neg_lo:[0,1] neg_hi:[0,1]
    v_pk_add_f32 v[110:111], s[36:37], v[206:207] neg_lo:[0,1] neg_hi:[0,1]
    v_perm_b32 v208, v97, v96, s38
    v_perm_b32 v209, v99, v98, s38
    v_perm_b32 v210, v101, v100, s38
    v_perm_b32 v211, v103, v102, s38
    v_perm_b32 v212, v105, v104, s38
    v_perm_b32 v213, v107, v106, s38
    v_perm_b32 v214, v109, v108, s38
    v_perm_b32 v215, v111, v110, s38
    ds_write_b128 v3, v[192:195] offset:0
    ds_write_b128 v3, v[196:199] offset:1024
    ds_write_b128 v3, v[200:203] offset:2048
    ds_write_b128 v3, v[204:207] offset:3072
    ds_write_b128 v3, v[208:211] offset:4096
    ds_write_b128 v3, v[212:215] offset:5120
    s_branch L_tab_done
L_tab_addr:
    v_lshrrev_b32 v10, 4, v1
    v_lshlrev_b32 v11, 13, v10
    v_and_b32 v12, 15, v1
    v_lshlrev_b32 v13, 4, v12
    v_add_u32 v85, v11, v13
    v_lshlrev_b32 v10, 2, v10
    v_and_b32 v11, 7, v12
    v_xor_b32 v10, v10, v11
    v_lshlrev_b32 v10, 4, v10
    v_lshlrev_b32 v12, 11, v12
    s_mov_b32 s36, 49152
    v_add3_u32 v86, v12, v10, s36
    ds_write_b128 v3, v[84:87] offset:9216
    v_lshrrev_b32 v11, 5, v1
    v_lshlrev_b32 v12, 2, v11
    v_subrev_u32 v223, 1, v11
    v_bfe_u32 v32, v1, 2, 2
    v_bfe_u32 v33, v1, 4, 1
    v_and_b32 v34, 3, v1
    v_lshlrev_b32 v34, 3, v34
    v_and_b32 v35, 15, v1
    v_add_u32 v36, v32, v12
    v_lshlrev_b32 v36, 6, v36
    v_lshlrev_b32 v37, 5, v33
    v_add3_u32 v216, v36, v37, v34
    v_lshlrev_b32 v36, 6, v35
    v_lshlrev_b32 v38, 4, v11
    v_add3_u32 v217, v36, v37, v38
    v_lshlrev_b32 v36, 12, v35
    v_add3_u32 v221, v36, v37, v38
    v_lshlrev_b32 v36, 15, v33
    v_lshlrev_b32 v38, 8, v11
    v_lshlrev_b32 v39, 4, v35
    v_add3_u32 v218, v36, v38, v39
    v_lshlrev_b32 v222, 7, v35
    v_lshlrev_b32 v36, 2, v33
    v_add_u32 v36, v36, v32
    v_lshrrev_b32 v38, 1, v36
    v_lshlrev_b32 v38, 5, v38
    v_lshlrev_b32 v39, 4, v11
    v_add_u32 v36, v36, v39
    v_lshlrev_b32 v36, 7, v36
    v_add3_u32 v220, v36, v38, v34
    v_and_b32 v36, 6, v8
    v_xor_b32 v36, v36, v9
    v_lshlrev_b32 v36, 4, v36
    v_lshl_add_u32 v219, v8, 11, v36
    ds_write_b128 v3, v[216:219] offset:6144
    ds_write_b128 v3, v[220:223] offset:7168
L_tab_done:
    s_call_b64 s[50:51], L_scalars
    s_lshl_b32 s36, s40, 12
    s_add_u32 s36, s36, 122880
    v_add_u32 v44, s36, v2
    v_xor_b32 v10, v9, v8
    v_lshlrev_b32 v10, 4, v10
    v_lshl_add_u32 v46, v8, 15, v10
    s_lshl_b32 s52, s40, 20
    s_lshl_b32 s37, s2, 7
    s_add_u32 s52, s52, s37
    s_add_u32 s52, s52, 12582912
    s_mul_i32 s36, s40, 262144
    s_add_u32 s36, s36, s37
    s_add_u32 s36, s36, 16777216
    s_cmp_lt_u32 s40, 2
    s_cselect_b32 s36, s36, 0x20000000
    v_add_u32 v47, s36, v2
    v_lshlrev_b32 v10, 26, v8
    v_or_b32 v47, v47, v10
    v_lshlrev_b32 v10, 28, v8
    v_or_b32 v47, v47, v10
    v_mov_b32 v40, 0
    v_mov_b32 v41, 0
    v_mov_b32 v42, 0
    v_mov_b32 v43, 0
    s_lshl_b32 s36, s2, 4
    s_add_u32 s36, s36, 17367040
    s_cmp_eq_u32 s40, 0
    s_cselect_b32 s36, s36, 0x20000000
    v_min_u32 v45, 1, v1
    v_lshlrev_b32 v45, 29, v45
    v_or_b32 v45, s36, v45
    s_lshl_b32 s53, s40, 10
    s_add_u32 s53, s53, 17367040
    s_and_b32 s36, s2, 7
    s_lshl_b32 s36, s36, 3
    s_lshr_b32 s37, s2, 5
    s_add_u32 s36, s36, s37
    s_lshl_b32 s65, s36, 16
    s_lshl_b32 s37, s40, 9
    s_add_u32 s65, s65, s37
    s_add_u32 s65, s65, 12582912
    s_add_u32 s66, s65, 32768
    s_add_u32 s67, s65, 4096
    s_add_u32 s68, s66, 4096
    s_barrier
    s_call_b64 s[50:51], L_issue
    s_waitcnt vmcnt(10)
    s_barrier
    s_call_b64 s[50:51], L_issue
    v_mov_b32 v6, 0
    buffer_load_dword v7, v6, s[28:31], 0 offen sc1
    s_lshl_b32 s36, s2, 2
    s_add_u32 s36, s36, s40
    s_lshl_b32 s36, s36, 11
    s_add_u32 s62, s16, s36
    s_addc_u32 s63, s17, 0
    s_lshr_b32 s69, s2, 3
    s_lshl_b32 s69, s69, 2
    s_add_u32 s69, s69, s40
    s_lshl_b32 s69, s69, 14
    s_and_b32 s37, s2, 1
    s_lshl_b32 s37, s37, 10
    s_add_u32 s69, s69, s37
    s_waitcnt vmcnt(11)
    s_waitcnt lgkmcnt(0)
    s_barrier
    ds_read_b128 v[192:195], v3 offset:0
    ds_read_b128 v[196:199], v3 offset:1024
    ds_read_b128 v[200:203], v3 offset:2048
    ds_read_b128 v[204:207], v3 offset:3072
    ds_read_b128 v[208:211], v3 offset:4096
    ds_read_b128 v[212:215], v3 offset:5120
    ds_read_b128 v[216:219], v3 offset:6144
    ds_read_b128 v[220:223], v3 offset:7168
    ds_read_b128 v[92:95], v3 offset:8192
    ds_read_b128 v[84:87], v3 offset:9216
    s_call_b64 s[50:51], L_issue
    s_waitcnt vmcnt(11)
    s_waitcnt lgkmcnt(0)
    s_barrier
    s_call_b64 s[50:51], L_issue
    s_load_dword s64, s[62:63], 0
    s_load_dword s64, s[62:63], 64
    s_load_dword s64, s[62:63], 128
    s_load_dword s64, s[62:63], 192
    s_waitcnt vmcnt(10)
    s_barrier
    ds_read_b128 v[16:19], v44 offset:0
    ds_read_b128 v[20:23], v44 offset:1024
    ds_read_b128 v[24:27], v44 offset:2048
    ds_read_b128 v[28:31], v44 offset:3072
    v_readfirstlane_b32 s35, v7
    s_cmp_eq_u32 s35, 0
    s_cbranch_scc1 L_pe
L_pe_done:
    s_call_b64 s[50:51], L_issue
    s_waitcnt lgkmcnt(0)
    s_load_dword s64, s[62:63], 256
    s_load_dword s64, s[62:63], 320
    s_load_dword s64, s[62:63], 384
    s_load_dword s64, s[62:63], 448
    buffer_store_dwordx4 v[16:19], v46, s[12:15], s52 offen sc1
    s_add_u32 s52, s52, 0x40000
    buffer_store_dwordx4 v[20:23], v46, s[12:15], s52 offen sc1
    s_add_u32 s52, s52, 0x40000
    buffer_store_dwordx4 v[24:27], v46, s[12:15], s52 offen sc1
    s_add_u32 s52, s52, 0x40000
    s_waitcnt vmcnt(13)
    s_barrier
    s_call_b64 s[50:51], L_issue
    s_load_dword s64, s[62:63], 512
    s_load_dword s64, s[62:63], 576
    s_load_dword s64, s[62:63], 640
    s_load_dword s64, s[62:63], 704
    buffer_store_dwordx4 v[28:31], v46, s[12:15], s52 offen sc1
    s_add_u32 s52, s52, 0x40000
    buffer_store_dwordx4 v[40:43], v47, s[12:15], 0 offen sc1
    s_waitcnt vmcnt(15)
    s_barrier
    s_call_b64 s[50:51], L_issue
    s_load_dword s64, s[62:63], 768
    s_load_dword s64, s[62:63], 832
    s_load_dword s64, s[62:63], 896
    s_load_dword s64, s[62:63], 960
    s_waitcnt vmcnt(12)
    s_barrier
    s_call_b64 s[50:51], L_issue
    s_load_dword s64, s[62:63], 1024
    s_load_dword s64, s[62:63], 1088
    s_load_dword s64, s[62:63], 1152
    s_load_dword s64, s[62:63], 1216
    s_waitcnt vmcnt(10)
    s_barrier
    buffer_store_dword v7, v45, s[12:15], 0 offen sc1
    s_call_b64 s[50:51], L_issue
    s_load_dword s64, s[62:63], 1280
    s_load_dword s64, s[62:63], 1344
    s_load_dword s64, s[62:63], 1408
    s_load_dword s64, s[62:63], 1472
    s_waitcnt vmcnt(11)
    s_barrier
    s_call_b64 s[50:51], L_issue
    s_load_dword s64, s[62:63], 1536
    s_load_dword s64, s[62:63], 1600
    s_load_dword s64, s[62:63], 1664
    s_load_dword s64, s[62:63], 1728
    s_waitcnt vmcnt(10)
    s_barrier
    s_call_b64 s[50:51], L_issue
    s_load_dword s64, s[62:63], 1792
    s_load_dword s64, s[62:63], 1856
    s_load_dword s64, s[62:63], 1920
    s_load_dword s64, s[62:63], 1984
    s_waitcnt vmcnt(10)
    s_barrier
    s_call_b64 s[50:51], L_issue
    s_load_dword s64, s[16:17], s69 offset:384
    s_load_dword s64, s[16:17], s69 offset:448
    s_load_dword s64, s[16:17], s69 offset:2432
    s_load_dword s64, s[16:17], s69 offset:2496
    s_waitcnt vmcnt(10)
    s_barrier
    s_call_b64 s[50:51], L_issue
    s_load_dword s64, s[16:17], s69 offset:4480
    s_load_dword s64, s[16:17], s69 offset:4544
    s_load_dword s64, s[16:17], s69 offset:6528
    s_load_dword s64, s[16:17], s69 offset:6592
    s_waitcnt vmcnt(10)
    s_barrier
    s_call_b64 s[50:51], L_issue
    s_load_dword s64, s[16:17], s69 offset:8576
    s_load_dword s64, s[16:17], s69 offset:8640
    s_load_dword s64, s[16:17], s69 offset:10624
    s_load_dword s64, s[16:17], s69 offset:10688
    buffer_load_dword v13, v2, s[12:15], s53 offen sc1
    s_waitcnt vmcnt(11)
    s_barrier
    s_call_b64 s[50:51], L_issue
    s_load_dword s64, s[16:17], s69 offset:12672
    s_load_dword s64, s[16:17], s69 offset:12736
    s_load_dword s64, s[16:17], s69 offset:14720
    s_load_dword s64, s[16:17], s69 offset:14784
    s_waitcnt vmcnt(10)
    v_cmp_ne_u32 vcc, s35, v13
    s_nop 4
    s_cbranch_vccz L_tfok
    s_mov_b32 s61, 262144
L_poll_1:
    buffer_load_dword v13, v2, s[12:15], s53 offen sc1
    s_waitcnt vmcnt(0)
    v_cmp_ne_u32 vcc, s35, v13
    s_nop 4
    s_cbranch_vccz L_polldone_2
    s_sleep 2
    s_sub_u32 s61, s61, 1
    s_cmp_lg_u32 s61, 0
    s_cbranch_scc1 L_poll_1
L_polldone_2:
L_tfok:
    s_barrier
    buffer_load_dwordx4 v[112:115], v85, s[12:15], s65 offen offset:0 sc1
    buffer_load_dwordx4 v[116:119], v85, s[12:15], s66 offen offset:0 sc1
    buffer_load_dwordx4 v[120:123], v85, s[12:15], s65 offen offset:2048 sc1
    buffer_load_dwordx4 v[124:127], v85, s[12:15], s66 offen offset:2048 sc1
    buffer_load_dwordx4 v[128:131], v85, s[12:15], s67 offen offset:0 sc1
    buffer_load_dwordx4 v[132:135], v85, s[12:15], s68 offen offset:0 sc1
    buffer_load_dwordx4 v[136:139], v85, s[12:15], s67 offen offset:2048 sc1
    buffer_load_dwordx4 v[140:143], v85, s[12:15], s68 offen offset:2048 sc1
    s_waitcnt vmcnt(8)
    s_barrier
    s_setprio 0
    buffer_load_dwordx4 v[144:147], v85, s[12:15], s65 offen offset:256 sc1
    buffer_load_dwordx4 v[148:151], v85, s[12:15], s66 offen offset:256 sc1
    buffer_load_dwordx4 v[152:155], v85, s[12:15], s65 offen offset:2304 sc1
    buffer_load_dwordx4 v[156:159], v85, s[12:15], s66 offen offset:2304 sc1
    buffer_load_dwordx4 v[160:163], v85, s[12:15], s67 offen offset:256 sc1
    buffer_load_dwordx4 v[164:167], v85, s[12:15], s68 offen offset:256 sc1
    buffer_load_dwordx4 v[168:171], v85, s[12:15], s67 offen offset:2304 sc1
    buffer_load_dwordx4 v[172:175], v85, s[12:15], s68 offen offset:2304 sc1
    s_lshl_b32 s36, s40, 9
    v_add_u32 v80, s36, v86
    v_xor_b32 v81, 16, v80
    v_xor_b32 v82, 32, v80
    v_xor_b32 v83, 48, v80
    v_mov_b32 v15, 0
    s_mov_b32 s36, 0x05040100
    s_mov_b32 s37, 0x07060302
    s_waitcnt vmcnt(8)
    v_perm_b32 v16, v116, v112, s36
    v_perm_b32 v17, v124, v120, s36
    v_perm_b32 v18, v132, v128, s36
    v_perm_b32 v19, v140, v136, s36
    v_perm_b32 v20, v116, v112, s37
    v_perm_b32 v21, v124, v120, s37
    v_perm_b32 v22, v132, v128, s37
    v_perm_b32 v23, v140, v136, s37
    v_perm_b32 v24, v117, v113, s36
    v_perm_b32 v25, v125, v121, s36
    v_perm_b32 v26, v133, v129, s36
    v_perm_b32 v27, v141, v137, s36
    v_perm_b32 v28, v117, v113, s37
    v_perm_b32 v29, v125, v121, s37
    v_perm_b32 v30, v133, v129, s37
    v_perm_b32 v31, v141, v137, s37
    v_perm_b32 v32, v118, v114, s36
    v_perm_b32 v33, v126, v122, s36
    v_perm_b32 v34, v134, v130, s36
    v_perm_b32 v35, v142, v138, s36
    v_perm_b32 v36, v118, v114, s37
    v_perm_b32 v37, v126, v122, s37
    v_perm_b32 v38, v134, v130, s37
    v_perm_b32 v39, v142, v138, s37
    v_perm_b32 v40, v119, v115, s36
    v_perm_b32 v41, v127, v123, s36
    v_perm_b32 v42, v135, v131, s36
    v_perm_b32 v43, v143, v139, s36
    v_perm_b32 v44, v119, v115, s37
    v_perm_b32 v45, v127, v123, s37
    v_perm_b32 v46, v135, v131, s37
    v_perm_b32 v47, v143, v139, s37
    s_waitcnt vmcnt(0)
    v_perm_b32 v48, v148, v144, s36
    v_perm_b32 v49, v156, v152, s36
    v_perm_b32 v50, v164, v160, s36
    v_perm_b32 v51, v172, v168, s36
    v_perm_b32 v52, v148, v144, s37
    v_perm_b32 v53, v156, v152, s37
    v_perm_b32 v54, v164, v160, s37
    v_perm_b32 v55, v172, v168, s37
    v_perm_b32 v56, v149, v145, s36
    v_perm_b32 v57, v157, v153, s36
    v_perm_b32 v58, v165, v161, s36
    v_perm_b32 v59, v173, v169, s36
    v_perm_b32 v60, v149, v145, s37
    v_perm_b32 v61, v157, v153, s37
    v_perm_b32 v62, v165, v161, s37
    v_perm_b32 v63, v173, v169, s37
    v_perm_b32 v64, v150, v146, s36
    v_perm_b32 v65, v158, v154, s36
    v_perm_b32 v66, v166, v162, s36
    v_perm_b32 v67, v174, v170, s36
    v_perm_b32 v68, v150, v146, s37
    v_perm_b32 v69, v158, v154, s37
    v_perm_b32 v70, v166, v162, s37
    v_perm_b32 v71, v174, v170, s37
    v_perm_b32 v72, v151, v147, s36
    v_perm_b32 v73, v159, v155, s36
    v_perm_b32 v74, v167, v163, s36
    v_perm_b32 v75, v175, v171, s36
    v_perm_b32 v76, v151, v147, s37
    v_perm_b32 v77, v159, v155, s37
    v_perm_b32 v78, v167, v163, s37
    v_perm_b32 v79, v175, v171, s37
    s_setprio 1
    v_mfma_f32_16x16x32_bf16 v[224:227], v[16:19], v[92:95], 0
    v_mfma_f32_16x16x32_bf16 v[228:231], v[20:23], v[92:95], 0
    v_mfma_f32_16x16x32_bf16 v[232:235], v[24:27], v[92:95], 0
    v_mfma_f32_16x16x32_bf16 v[236:239], v[28:31], v[92:95], 0
    v_mfma_f32_16x16x32_bf16 v[240:243], v[32:35], v[92:95], 0
    v_mfma_f32_16x16x32_bf16 v[244:247], v[36:39], v[92:95], 0
    v_mfma_f32_16x16x32_bf16 v[248:251], v[40:43], v[92:95], 0
    v_mfma_f32_16x16x32_bf16 v[252:255], v[44:47], v[92:95], 0
    v_mfma_f32_16x16x32_bf16 v[112:115], v[48:51], v[92:95], 0
    v_mfma_f32_16x16x32_bf16 v[116:119], v[52:55], v[92:95], 0
    v_mfma_f32_16x16x32_bf16 v[120:123], v[56:59], v[92:95], 0
    v_mfma_f32_16x16x32_bf16 v[124:127], v[60:63], v[92:95], 0
    v_mfma_f32_16x16x32_bf16 v[128:131], v[64:67], v[92:95], 0
    v_mfma_f32_16x16x32_bf16 v[132:135], v[68:71], v[92:95], 0
    v_mfma_f32_16x16x32_bf16 v[136:139], v[72:75], v[92:95], 0
    v_mfma_f32_16x16x32_bf16 v[140:143], v[76:79], v[92:95], 0
    s_setprio 0
    v_cvt_pk_bf16_f32 v144, v224, v228
    v_cvt_pk_bf16_f32 v145, v232, v236
    v_cvt_pk_bf16_f32 v146, v240, v244
    v_cvt_pk_bf16_f32 v147, v248, v252
    ds_write_b128 v80, v[144:147] offset:0
    v_cvt_pk_bf16_f32 v148, v225, v229
    v_cvt_pk_bf16_f32 v149, v233, v237
    v_cvt_pk_bf16_f32 v150, v241, v245
    v_cvt_pk_bf16_f32 v151, v249, v253
    ds_write_b128 v81, v[148:151] offset:0
    v_cvt_pk_bf16_f32 v152, v226, v230
    v_cvt_pk_bf16_f32 v153, v234, v238
    v_cvt_pk_bf16_f32 v154, v242, v246
    v_cvt_pk_bf16_f32 v155, v250, v254
    ds_write_b128 v82, v[152:155] offset:0
    v_cvt_pk_bf16_f32 v156, v227, v231
    v_cvt_pk_bf16_f32 v157, v235, v239
    v_cvt_pk_bf16_f32 v158, v243, v247
    v_cvt_pk_bf16_f32 v159, v251, v255
    ds_write_b128 v83, v[156:159] offset:0
    v_cvt_pk_bf16_f32 v160, v112, v116
    v_cvt_pk_bf16_f32 v161, v120, v124
    v_cvt_pk_bf16_f32 v162, v128, v132
    v_cvt_pk_bf16_f32 v163, v136, v140
    ds_write_b128 v80, v[160:163] offset:256
    v_cvt_pk_bf16_f32 v164, v113, v117
    v_cvt_pk_bf16_f32 v165, v121, v125
    v_cvt_pk_bf16_f32 v166, v129, v133
    v_cvt_pk_bf16_f32 v167, v137, v141
    ds_write_b128 v81, v[164:167] offset:256
    v_cvt_pk_bf16_f32 v168, v114, v118
    v_cvt_pk_bf16_f32 v169, v122, v126
    v_cvt_pk_bf16_f32 v170, v130, v134
    v_cvt_pk_bf16_f32 v171, v138, v142
    ds_write_b128 v82, v[168:171] offset:256
    v_cvt_pk_bf16_f32 v172, v115, v119
    v_cvt_pk_bf16_f32 v173, v123, v127
    v_cvt_pk_bf16_f32 v174, v131, v135
    v_cvt_pk_bf16_f32 v175, v139, v143
    ds_write_b128 v83, v[172:175] offset:256
    s_waitcnt lgkmcnt(0)
    s_barrier
    s_setprio 1
    v_mov_b32 v15, 0
    s_mov_b64 exec, 1
    buffer_atomic_or v15, v2, s[12:15], s23 offen sc0 sc1
    s_mov_b64 exec, -1
    s_branch L_join
L_pe:
    s_mov_b32 s61, 262144
L_pe2:
    buffer_load_dword v7, v6, s[28:31], 0 offen sc1
    s_waitcnt vmcnt(0)
    v_readfirstlane_b32 s35, v7
    s_sub_u32 s61, s61, 1
    s_cbranch_scc1 L_pe_done
    s_cmp_eq_u32 s35, 0
    s_cbranch_scc1 L_pe2
    s_branch L_pe_done
L_scalars:
    s_and_b32 s36, s2, 7
    s_lshl_b32 s36, s36, 3
    s_lshr_b32 s37, s2, 5
    s_add_u32 s36, s36, s37
    s_lshr_b32 s37, s2, 3
    s_and_b32 s38, s37, 1
    s_bfe_u32 s37, s37, 0x10001
    s_sub_u32 s0, 128, s36
    s_cmp_eq_u32 s36, 0
    s_cselect_b32 s0, 64, s0
    s_cmp_eq_u32 s37, 0
    s_cselect_b32 s0, s36, s0
    s_lshl_b32 s38, s38, 3
    s_add_u32 s38, s38, s32
    s_lshl_b32 s38, s38, 7
    s_add_u32 s0, s0, s38
    s_lshl_b32 s0, s0, 12
    s_lshr_b32 s36, s32, 1
    s_lshl_b32 s37, s33, 2
    s_add_u32 s37, s37, s36
    s_sub_u32 s54, 8, s37
    s_max_i32 s54, s54, 0
    s_and_b32 s36, s32, 1
    s_lshl_b32 s38, s34, 1
    s_add_u32 s36, s36, s38
    s_lshl_b32 s1, s37, 16
    s_lshl_b32 s38, s36, 10
    s_add_u32 s1, s1, s38
    s_add_u32 s1, s1, 8388608
    s_lshl_b32 s38, s37, 1
    s_lshr_b32 s52, s36, 4
    s_add_u32 s38, s38, s52
    s_lshl_b32 s38, s38, 7
    s_add_u32 s3, s38, 17039360
    s_and_b32 s52, s36, 15
    s_add_u32 s3, s3, s52
    s_bfe_u32 s36, s2, 0x20001
    s_lshl_b32 s36, s36, 2
    s_bfe_u32 s37, s2, 0x20003
    s_add_u32 s36, s36, s37
    s_and_b32 s38, s2, 1
    s_lshl_b32 s38, s38, 3
    s_lshr_b32 s37, s2, 5
    s_add_u32 s38, s38, s37
    s_lshl_b32 s36, s36, 2
    s_lshr_b32 s37, s32, 2
    s_lshl_b32 s37, s37, 1
    s_add_u32 s36, s36, s37
    s_and_b32 s37, s32, 1
    s_add_u32 s36, s36, s37
    s_bfe_u32 s37, s32, 0x10001
    s_lshl_b32 s56, s32, 10
    s_lshl_b32 s38, s38, 7
    s_lshl_b32 s55, s32, 14
    s_add_u32 s55, s55, s38
    s_lshl_b32 s52, s36, 1
    s_add_u32 s52, s52, s37
    s_lshl_b32 s57, s52, 7
    s_add_u32 s57, s57, 17039360
    s_lshl_b32 s60, s52, 16
    s_add_u32 s60, s60, s38
    s_lshl_b32 s52, s36, 16
    s_lshl_b32 s53, s37, 14
    s_add_u32 s52, s52, s53
    s_add_u32 s52, s52, 8388608
    s_lshl_b32 s53, s37, 15
    s_add_u32 s58, s52, s53
    s_xor_b32 s53, s53, 32768
    s_add_u32 s59, s52, s53
    s_lshl_b32 s36, s33, 4
    s_add_u32 s36, s36, s34
    s_bfe_u32 s38, s32, 0x10001
    s_lshl_b32 s38, s38, 13
    s_and_b32 s37, s32, 1
    s_lshl_b32 s37, s37, 11
    s_add_u32 s20, s38, s37
    s_lshl_b32 s52, s36, 14
    s_add_u32 s52, s52, s20
    s_lshl_b32 s36, s36, 7
    s_add_u32 s23, s36, 16777216
    s_cmp_ge_u32 s33, 1
    s_cselect_b32 s36, 262144, 0
    s_sub_u32 s22, s52, s36
    s_cmp_ge_u32 s33, 2
    s_cselect_b32 s36, 524288, 0
    s_sub_u32 s21, s52, s36
    s_setpc_b64 s[50:51]
L_cons:
    s_memrealtime s[60:61]
    v_and_b32 v11, 1, v10
    v_lshlrev_b32 v11, 2, v11
    v_xor_b32 v11, v11, v9
    v_lshlrev_b32 v11, 4, v11
    v_lshlrev_b32 v12, 15, v8
    v_add_u32 v6, v11, v12
    s_lshl_b32 s36, s2, 7
    s_lshl_b32 s37, s32, 18
    s_add_u32 s36, s36, s37
    s_lshl_b32 s37, s32, 10
    s_mov_b32 s22, 4194304
    s_mov_b32 s23, 0x20000
    s_waitcnt lgkmcnt(0)
    s_mov_b64 s[4:5], s[40:41]
    s_mov_b64 s[8:9], s[42:43]
    s_mov_b64 s[16:17], s[44:45]
    s_mov_b64 s[20:21], s[46:47]
    s_mov_b64 s[24:25], s[48:49]
    s_mov_b64 s[28:29], s[50:51]
    s_mov_b64 s[12:13], s[52:53]
    s_add_u32 m0, s37, 122880
    s_add_u32 s48, s36, 0
    buffer_load_dwordx4 v6, s[20:23], s48 offen nt lds
    s_add_u32 m0, s37, 126976
    s_add_u32 s48, s36, 1048576
    buffer_load_dwordx4 v6, s[20:23], s48 offen nt lds
    s_add_u32 m0, s37, 131072
    s_add_u32 s48, s36, 2097152
    buffer_load_dwordx4 v6, s[20:23], s48 offen nt lds
    s_add_u32 m0, s37, 135168
    s_add_u32 s48, s36, 3145728
    buffer_load_dwordx4 v6, s[20:23], s48 offen nt lds
    s_mov_b32 s6, 4194304
    s_mov_b32 s7, 0x20000
    s_mov_b32 s10, 6291456
    s_mov_b32 s11, 0x20000
    s_mov_b32 s18, 2097152
    s_mov_b32 s19, 0x20000
    s_mov_b32 s26, 8388608
    s_mov_b32 s27, 0x20000
    s_mov_b32 s30, 256
    s_mov_b32 s31, 0x20000
    s_mov_b32 s14, 268435456
    s_mov_b32 s15, 0x20000
    s_cmp_lg_u32 s32, 3
    s_cbranch_scc1 L_nohelp
    s_and_b32 s36, s34, 7
    s_cmp_ge_u32 s36, 3
    s_cbranch_scc1 L_nohelp
    s_or_b32 s37, s34, 3
    s_lshl_b32 s38, s33, 1
    s_add_u32 s38, s38, 1
    s_and_b32 s38, s38, 15
    s_mul_i32 s38, s38, 393216
    s_lshl_b32 s36, s36, 11
    s_add_u32 s38, s38, s36
    s_lshl_b32 s37, s37, 7
    s_add_u32 s38, s38, s37
    v_mul_u32_u24 v4, 6144, v1
    buffer_load_dword v0, v4, s[8:11], s38 offen
L_nohelp:
    s_or_b32 s36, s2, s32
    s_cmp_lg_u32 s36, 0
    s_cbranch_scc1 L_noepoch
    s_or_b32 s60, s60, 1
    v_mov_b32 v4, s60
    v_mov_b32 v5, 0
    s_mov_b64 exec, 1
    buffer_store_dword v4, v5, s[28:31], 0 offen sc1
    s_mov_b64 exec, -1
L_noepoch:
    v_and_b32 v8, 31, v1
    s_lshl_b32 s36, s32, 5
    v_add_u32 v8, s36, v8
    v_lshrrev_b32 v9, 1, v8
    v_and_b32 v10, 1, v8
    v_cmp_eq_u32 vcc, 1, v8
    s_nop 1
    v_cndmask_b32 v9, v9, 64, vcc
    v_cndmask_b32 v10, v10, 0, vcc
    v_cvt_f32_u32 v9, v9
    v_mul_f32 v9, 1006632960, v9
    v_cvt_f32_u32 v10, v10
    v_mul_f32 v10, 1048576000, v10
    v_lshrrev_b32 v11, 5, v1
    v_lshlrev_b32 v11, 3, v11
    v_cvt_f32_u32 v11, v11
    v_fma_f32 v16, v9, v11, v10
    v_mul_f32 v12, 1098907648, v9
    v_mov_b32 v13, v12
    v_add_f32 v17, v16, v9
    v_add_f32 v18, v17, v9
    v_add_f32 v19, v18, v9
    v_add_f32 v20, v19, v9
    v_add_f32 v21, v20, v9
    v_add_f32 v22, v21, v9
    v_add_f32 v23, v22, v9
    v_cos_f32 v24, v16
    v_cos_f32 v25, v17
    v_cos_f32 v26, v18
    v_cos_f32 v27, v19
    v_cos_f32 v28, v20
    v_cos_f32 v29, v21
    v_cos_f32 v30, v22
    v_cos_f32 v31, v23
    v_pk_add_f32 v[16:17], v[16:17], v[12:13]
    v_pk_add_f32 v[18:19], v[18:19], v[12:13]
    v_pk_add_f32 v[20:21], v[20:21], v[12:13]
    v_pk_add_f32 v[22:23], v[22:23], v[12:13]
    v_cvt_pk_bf16_f32 v192, v24, v25
    v_cvt_pk_bf16_f32 v193, v26, v27
    v_cvt_pk_bf16_f32 v194, v28, v29
    v_cvt_pk_bf16_f32 v195, v30, v31
    v_cos_f32 v24, v16
    v_cos_f32 v25, v17
    v_cos_f32 v26, v18
    v_cos_f32 v27, v19
    v_cos_f32 v28, v20
    v_cos_f32 v29, v21
    v_cos_f32 v30, v22
    v_cos_f32 v31, v23
    v_pk_add_f32 v[16:17], v[16:17], v[12:13]
    v_pk_add_f32 v[18:19], v[18:19], v[12:13]
    v_pk_add_f32 v[20:21], v[20:21], v[12:13]
    v_pk_add_f32 v[22:23], v[22:23], v[12:13]
    v_cvt_pk_bf16_f32 v196, v24, v25
    v_cvt_pk_bf16_f32 v197, v26, v27
    v_cvt_pk_bf16_f32 v198, v28, v29
    v_cvt_pk_bf16_f32 v199, v30, v31
    v_cos_f32 v24, v16
    v_cos_f32 v25, v17
    v_cos_f32 v26, v18
    v_cos_f32 v27, v19
    v_cos_f32 v28, v20
    v_cos_f32 v29, v21
    v_cos_f32 v30, v22
    v_cos_f32 v31, v23
    v_pk_add_f32 v[16:17], v[16:17], v[12:13]
    v_pk_add_f32 v[18:19], v[18:19], v[12:13]
    v_pk_add_f32 v[20:21], v[20:21], v[12:13]
    v_pk_add_f32 v[22:23], v[22:23], v[12:13]
    v_cvt_pk_bf16_f32 v200, v24, v25
    v_cvt_pk_bf16_f32 v201, v26, v27
    v_cvt_pk_bf16_f32 v202, v28, v29
    v_cvt_pk_bf16_f32 v203, v30, v31
    v_cos_f32 v24, v16
    v_cos_f32 v25, v17
    v_cos_f32 v26, v18
    v_cos_f32 v27, v19
    v_cos_f32 v28, v20
    v_cos_f32 v29, v21
    v_cos_f32 v30, v22
    v_cos_f32 v31, v23
    v_pk_add_f32 v[16:17], v[16:17], v[12:13]
    v_pk_add_f32 v[18:19], v[18:19], v[12:13]
    v_pk_add_f32 v[20:21], v[20:21], v[12:13]
    v_pk_add_f32 v[22:23], v[22:23], v[12:13]
    v_cvt_pk_bf16_f32 v204, v24, v25
    v_cvt_pk_bf16_f32 v205, v26, v27
    v_cvt_pk_bf16_f32 v206, v28, v29
    v_cvt_pk_bf16_f32 v207, v30, v31
    v_cos_f32 v24, v16
    v_cos_f32 v25, v17
    v_cos_f32 v26, v18
    v_cos_f32 v27, v19
    v_cos_f32 v28, v20
    v_cos_f32 v29, v21
    v_cos_f32 v30, v22
    v_cos_f32 v31, v23
    v_pk_add_f32 v[16:17], v[16:17], v[12:13]
    v_pk_add_f32 v[18:19], v[18:19], v[12:13]
    v_pk_add_f32 v[20:21], v[20:21], v[12:13]
    v_pk_add_f32 v[22:23], v[22:23], v[12:13]
    v_cvt_pk_bf16_f32 v208, v24, v25
    v_cvt_pk_bf16_f32 v209, v26, v27
    v_cvt_pk_bf16_f32 v210, v28, v29
    v_cvt_pk_bf16_f32 v211, v30, v31
    v_cos_f32 v24, v16
    v_cos_f32 v25, v17
    v_cos_f32 v26, v18
    v_cos_f32 v27, v19
    v_cos_f32 v28, v20
    v_cos_f32 v29, v21
    v_cos_f32 v30, v22
    v_cos_f32 v31, v23
    v_pk_add_f32 v[16:17], v[16:17], v[12:13]
    v_pk_add_f32 v[18:19], v[18:19], v[12:13]
    v_pk_add_f32 v[20:21], v[20:21], v[12:13]
    v_pk_add_f32 v[22:23], v[22:23], v[12:13]
    v_cvt_pk_bf16_f32 v212, v24, v25
    v_cvt_pk_bf16_f32 v213, v26, v27
    v_cvt_pk_bf16_f32 v214, v28, v29
    v_cvt_pk_bf16_f32 v215, v30, v31
    v_cos_f32 v24, v16
    v_cos_f32 v25, v17
    v_cos_f32 v26, v18
    v_cos_f32 v27, v19
    v_cos_f32 v28, v20
    v_cos_f32 v29, v21
    v_cos_f32 v30, v22
    v_cos_f32 v31, v23
    v_pk_add_f32 v[16:17], v[16:17], v[12:13]
    v_pk_add_f32 v[18:19], v[18:19], v[12:13]
    v_pk_add_f32 v[20:21], v[20:21], v[12:13]
    v_pk_add_f32 v[22:23], v[22:23], v[12:13]
    v_cvt_pk_bf16_f32 v216, v24, v25
    v_cvt_pk_bf16_f32 v217, v26, v27
    v_cvt_pk_bf16_f32 v218, v28, v29
    v_cvt_pk_bf16_f32 v219, v30, v31
    v_cos_f32 v24, v16
    v_cos_f32 v25, v17
    v_cos_f32 v26, v18
    v_cos_f32 v27, v19
    v_cos_f32 v28, v20
    v_cos_f32 v29, v21
    v_cos_f32 v30, v22
    v_cos_f32 v31, v23
    v_cvt_pk_bf16_f32 v220, v24, v25
    v_cvt_pk_bf16_f32 v221, v26, v27
    v_cvt_pk_bf16_f32 v222, v28, v29
    v_cvt_pk_bf16_f32 v223, v30, v31
    v_lshrrev_b32 v8, 4, v1
    v_and_b32 v9, 1, v8
    v_lshlrev_b32 v9, 1, v9
    v_bfe_u32 v10, v1, 1, 1
    v_add_u32 v9, v9, v10
    v_bfe_u32 v10, v1, 3, 1
    v_lshlrev_b32 v10, 2, v10
    v_xor_b32 v9, v9, v10
    v_lshlrev_b32 v9, 4, v9
    v_and_b32 v10, 1, v1
    v_lshlrev_b32 v10, 3, v10
    v_add_u32 v9, v9, v10
    v_bfe_u32 v10, v1, 2, 2
    v_lshrrev_b32 v11, 5, v1
    v_lshlrev_b32 v12, 3, v11
    v_add_u32 v10, v10, v12
    v_lshlrev_b32 v10, 7, v10
    v_add_u32 v9, v9, v10
    v_add_u32 v84, 122880, v9
    v_xor_b32 v85, 64, v84
    s_lshl_b32 s36, s32, 12
    s_add_u32 s36, s36, 122880
    v_and_b32 v8, 31, v1
    v_and_b32 v12, 7, v8
    v_xor_b32 v12, v12, v11
    v_lshlrev_b32 v12, 4, v12
    v_lshlrev_b32 v8, 7, v8
    v_add3_u32 v80, v12, v8, s36
    v_xor_b32 v81, 32, v80
    v_xor_b32 v82, 64, v80
    v_xor_b32 v83, 0x60, v80
    s_call_b64 s[50:51], L_scalars
    s_lshr_b32 s40, s32, 1
    s_and_b32 s41, s32, 1
    v_and_b32 v8, 15, v1
    v_lshrrev_b32 v9, 4, v1
    v_lshrrev_b32 v10, 1, v8
    v_xor_b32 v10, v10, v9
    v_lshlrev_b32 v10, 4, v10
    v_and_b32 v11, 8, v8
    v_add_u32 v11, v11, v8
    v_lshlrev_b32 v12, 7, v11
    v_add_u32 v10, v10, v12
    s_lshl_b32 s36, s40, 13
    v_add_u32 v4, s36, v10
    v_xor_b32 v5, 64, v4
    v_bfe_u32 v10, v1, 3, 1
    v_and_b32 v12, 1, v9
    v_lshlrev_b32 v12, 1, v12
    v_or_b32 v10, v10, v12
    s_lshl_b32 s36, s41, 1
    v_xor_b32 v10, s36, v10
    v_lshlrev_b32 v10, 5, v10
    v_and_b32 v12, 3, v1
    v_lshlrev_b32 v12, 3, v12
    v_add_u32 v10, v10, v12
    v_bfe_u32 v12, v1, 2, 2
    v_lshlrev_b32 v13, 3, v9
    v_add_u32 v12, v12, v13
    v_lshlrev_b32 v12, 7, v12
    v_add_u32 v10, v10, v12
    v_add_u32 v6, 16384, v10
    v_xor_b32 v7, 32, v6
    v_lshrrev_b32 v12, 1, v9
    v_lshlrev_b32 v12, 10, v12
    v_and_b32 v13, 1, v9
    v_lshlrev_b32 v13, 9, v13
    v_add_u32 v12, v12, v13
    v_lshlrev_b32 v13, 4, v11
    v_add_u32 v14, v12, v13
    v_lshlrev_b32 v13, 4, v8
    v_add_u32 v15, v12, v13
    v_add_u32 v3, 139264, v2
    s_lshl_b32 s36, s33, 4
    s_add_u32 s36, s36, s34
    s_lshl_b32 s48, s36, 14
    s_lshl_b32 s38, s40, 13
    s_lshl_b32 s44, s41, 11
    s_add_u32 s38, s38, s44
    s_add_u32 s48, s48, s38
    s_add_u32 s49, s48, 4096
    s_add_u32 s50, s48, 4194304
    s_add_u32 s51, s49, 4194304
    s_add_u32 s52, s38, 114688
    s_add_u32 s53, s38, 32768
    s_add_u32 s40, s38, 131072
    s_add_u32 s46, s23, 2048
    s_sub_u32 s47, 15, s33
    s_min_u32 s47, s47, 2
    s_bfm_b32 s47, s47, 0
    s_cmp_eq_u32 s32, 3
    s_cbranch_scc1 L_bxw
    s_waitcnt vmcnt(0)
L_bxw:
    s_waitcnt vmcnt(1)
    s_and_b32 s36, s34, 7
    s_cmp_lt_u32 s36, 3
    s_cbranch_scc1 L_bxw2
    s_waitcnt vmcnt(0)
L_bxw2:
    s_barrier
    ds_read_b64_tr_b16 v[16:17], v84 offset:0
    ds_read_b64_tr_b16 v[18:19], v84 offset:512
    ds_read_b64_tr_b16 v[48:49], v85 offset:0
    ds_read_b64_tr_b16 v[50:51], v85 offset:512
    ds_read_b64_tr_b16 v[20:21], v84 offset:2048
    ds_read_b64_tr_b16 v[22:23], v84 offset:2560
    ds_read_b64_tr_b16 v[52:53], v85 offset:2048
    ds_read_b64_tr_b16 v[54:55], v85 offset:2560
    ds_read_b64_tr_b16 v[24:25], v84 offset:4096
    ds_read_b64_tr_b16 v[26:27], v84 offset:4608
    ds_read_b64_tr_b16 v[56:57], v85 offset:4096
    ds_read_b64_tr_b16 v[58:59], v85 offset:4608
    s_waitcnt lgkmcnt(8)
    v_mfma_f32_32x32x16_bf16 v[224:239], v[16:19], v[192:195], 0
    v_mov_b32 v191, 0
    v_mov_b32 v190, 0
    v_mov_b32 v189, 0
    v_mov_b32 v188, 0
    v_mov_b32 v187, 0
    v_mov_b32 v186, 0
    v_mfma_f32_32x32x16_bf16 v[240:255], v[48:51], v[192:195], 0
    v_mov_b32 v185, 0
    v_mov_b32 v184, 0
    v_mov_b32 v183, 0
    v_mov_b32 v182, 0
    v_mov_b32 v181, 0
    v_mov_b32 v180, 0
    ds_read_b64_tr_b16 v[28:29], v84 offset:6144
    ds_read_b64_tr_b16 v[30:31], v84 offset:6656
    ds_read_b64_tr_b16 v[60:61], v85 offset:6144
    ds_read_b64_tr_b16 v[62:63], v85 offset:6656
    s_waitcnt lgkmcnt(8)
    v_mfma_f32_32x32x16_bf16 v[224:239], v[20:23], v[196:199], v[224:239]
    v_mov_b32 v179, 0
    v_mov_b32 v178, 0
    v_mov_b32 v177, 0
    v_mov_b32 v176, 0
    v_mov_b32 v175, 0
    v_mov_b32 v174, 0
    v_mfma_f32_32x32x16_bf16 v[240:255], v[52:55], v[196:199], v[240:255]
    v_mov_b32 v173, 0
    v_mov_b32 v172, 0
    v_mov_b32 v171, 0
    v_mov_b32 v170, 0
    v_mov_b32 v169, 0
    v_mov_b32 v168, 0
    ds_read_b64_tr_b16 v[32:33], v84 offset:8192
    ds_read_b64_tr_b16 v[34:35], v84 offset:8704
    ds_read_b64_tr_b16 v[64:65], v85 offset:8192
    ds_read_b64_tr_b16 v[66:67], v85 offset:8704
    s_waitcnt lgkmcnt(8)
    v_mfma_f32_32x32x16_bf16 v[224:239], v[24:27], v[200:203], v[224:239]
    v_mov_b32 v167, 0
    v_mov_b32 v166, 0
    v_mov_b32 v165, 0
    v_mov_b32 v164, 0
    v_mov_b32 v163, 0
    v_mov_b32 v162, 0
    v_mfma_f32_32x32x16_bf16 v[240:255], v[56:59], v[200:203], v[240:255]
    v_mov_b32 v161, 0
    v_mov_b32 v160, 0
    v_mov_b32 v159, 0
    v_mov_b32 v158, 0
    v_mov_b32 v157, 0
    v_mov_b32 v156, 0
    ds_read_b64_tr_b16 v[36:37], v84 offset:10240
    ds_read_b64_tr_b16 v[38:39], v84 offset:10752
    ds_read_b64_tr_b16 v[68:69], v85 offset:10240
    ds_read_b64_tr_b16 v[70:71], v85 offset:10752
    s_waitcnt lgkmcnt(8)
    v_mfma_f32_32x32x16_bf16 v[224:239], v[28:31], v[204:207], v[224:239]
    v_mov_b32 v155, 0
    v_mov_b32 v154, 0
    v_mov_b32 v153, 0
    v_mov_b32 v152, 0
    v_mov_b32 v151, 0
    v_mov_b32 v150, 0
    v_mfma_f32_32x32x16_bf16 v[240:255], v[60:63], v[204:207], v[240:255]
    v_mov_b32 v149, 0
    v_mov_b32 v148, 0
    v_mov_b32 v147, 0
    v_mov_b32 v146, 0
    v_mov_b32 v145, 0
    v_mov_b32 v144, 0
    ds_read_b64_tr_b16 v[40:41], v84 offset:12288
    ds_read_b64_tr_b16 v[42:43], v84 offset:12800
    ds_read_b64_tr_b16 v[72:73], v85 offset:12288
    ds_read_b64_tr_b16 v[74:75], v85 offset:12800
    s_waitcnt lgkmcnt(8)
    v_mfma_f32_32x32x16_bf16 v[224:239], v[32:35], v[208:211], v[224:239]
    v_mov_b32 v143, 0
    v_mov_b32 v142, 0
    v_mov_b32 v141, 0
    v_mov_b32 v140, 0
    v_mov_b32 v139, 0
    v_mov_b32 v138, 0
    v_mfma_f32_32x32x16_bf16 v[240:255], v[64:67], v[208:211], v[240:255]
    v_mov_b32 v137, 0
    v_mov_b32 v136, 0
    v_mov_b32 v135, 0
    v_mov_b32 v134, 0
    v_mov_b32 v133, 0
    v_mov_b32 v132, 0
    ds_read_b64_tr_b16 v[44:45], v84 offset:14336
    ds_read_b64_tr_b16 v[46:47], v84 offset:14848
    ds_read_b64_tr_b16 v[76:77], v85 offset:14336
    ds_read_b64_tr_b16 v[78:79], v85 offset:14848
    s_waitcnt lgkmcnt(8)
    v_mfma_f32_32x32x16_bf16 v[224:239], v[36:39], v[212:215], v[224:239]
    v_mov_b32 v131, 0
    v_mov_b32 v130, 0
    v_mov_b32 v129, 0
    v_mov_b32 v128, 0
    v_mov_b32 v127, 0
    v_mov_b32 v126, 0
    v_mfma_f32_32x32x16_bf16 v[240:255], v[68:71], v[212:215], v[240:255]
    v_mov_b32 v125, 0
    v_mov_b32 v124, 0
    v_mov_b32 v123, 0
    v_mov_b32 v122, 0
    v_mov_b32 v121, 0
    v_mov_b32 v120, 0
    s_waitcnt lgkmcnt(4)
    v_mfma_f32_32x32x16_bf16 v[224:239], v[40:43], v[216:219], v[224:239]
    v_mov_b32 v119, 0
    v_mov_b32 v118, 0
    v_mov_b32 v117, 0
    v_mov_b32 v116, 0
    v_mov_b32 v115, 0
    v_mov_b32 v114, 0
    v_mfma_f32_32x32x16_bf16 v[240:255], v[72:75], v[216:219], v[240:255]
    v_mov_b32 v113, 0
    v_mov_b32 v112, 0
    v_mov_b32 v111, 0
    v_mov_b32 v110, 0
    v_mov_b32 v109, 0
    v_mov_b32 v108, 0
    s_waitcnt lgkmcnt(0)
    v_mfma_f32_32x32x16_bf16 v[224:239], v[44:47], v[220:223], v[224:239]
    v_mov_b32 v107, 0
    v_mov_b32 v106, 0
    v_mov_b32 v105, 0
    v_mov_b32 v104, 0
    v_mov_b32 v103, 0
    v_mov_b32 v102, 0
    v_mfma_f32_32x32x16_bf16 v[240:255], v[76:79], v[220:223], v[240:255]
    v_mov_b32 v101, 0
    v_mov_b32 v100, 0
    v_mov_b32 v99, 0
    v_mov_b32 v98, 0
    v_mov_b32 v97, 0
    v_mov_b32 v96, 0
    v_cvt_pk_bf16_f32 v192, v224, v225
    v_cvt_pk_bf16_f32 v193, v226, v227
    v_cvt_pk_bf16_f32 v194, v228, v229
    v_cvt_pk_bf16_f32 v195, v230, v231
    v_cvt_pk_bf16_f32 v196, v232, v233
    v_cvt_pk_bf16_f32 v197, v234, v235
    v_cvt_pk_bf16_f32 v198, v236, v237
    v_cvt_pk_bf16_f32 v199, v238, v239
    v_permlane32_swap_b32 v192, v194
    v_permlane32_swap_b32 v193, v195
    v_permlane32_swap_b32 v196, v198
    v_permlane32_swap_b32 v197, v199
    v_cvt_pk_bf16_f32 v200, v240, v241
    v_cvt_pk_bf16_f32 v201, v242, v243
    v_cvt_pk_bf16_f32 v202, v244, v245
    v_cvt_pk_bf16_f32 v203, v246, v247
    v_cvt_pk_bf16_f32 v204, v248, v249
    v_cvt_pk_bf16_f32 v205, v250, v251
    v_cvt_pk_bf16_f32 v206, v252, v253
    v_cvt_pk_bf16_f32 v207, v254, v255
    v_permlane32_swap_b32 v200, v202
    v_permlane32_swap_b32 v201, v203
    v_permlane32_swap_b32 v204, v206
    v_permlane32_swap_b32 v205, v207
    s_mov_b32 s42, 0
    s_mov_b32 s43, 14
    s_barrier
    ds_read_b64_tr_b16 v[48:49], v6 offset:0
    ds_read_b64_tr_b16 v[50:51], v6 offset:512
    ds_read_b128 v[16:19], v4 offset:0
    ds_read_b128 v[20:23], v4 offset:1024
    ds_read_b128 v[24:27], v4 offset:4096
    ds_read_b128 v[28:31], v4 offset:5120
    ds_read_b64_tr_b16 v[52:53], v7 offset:0
    ds_read_b64_tr_b16 v[54:55], v7 offset:512
    ds_read_b64_tr_b16 v[56:57], v6 offset:8192
    ds_read_b64_tr_b16 v[58:59], v6 offset:8704
    ds_read_b64_tr_b16 v[60:61], v7 offset:8192
    ds_read_b64_tr_b16 v[62:63], v7 offset:8704
    ds_read_b64_tr_b16 v[64:65], v6 offset:16384
    ds_read_b64_tr_b16 v[66:67], v6 offset:16896
    ds_read_b64_tr_b16 v[68:69], v7 offset:16384
    ds_read_b64_tr_b16 v[70:71], v7 offset:16896
    ds_write_b128 v80, v[192:195]
    ds_write_b128 v81, v[196:199]
    ds_write_b128 v82, v[200:203]
    ds_write_b128 v83, v[204:207]
.p2align 6
L_cloop:
    s_waitcnt lgkmcnt(0)
    v_mfma_f32_16x16x32_bf16 v[96:99], v[48:51], v[16:19], v[96:99]
    ds_read_b64_tr_b16 v[72:73], v6 offset:4096
    v_mfma_f32_16x16x32_bf16 v[104:107], v[48:51], v[20:23], v[104:107]
    ds_read_b64_tr_b16 v[74:75], v6 offset:4608
    v_mfma_f32_16x16x32_bf16 v[112:115], v[48:51], v[24:27], v[112:115]
    ds_read_b128 v[32:35], v5 offset:0
    v_mfma_f32_16x16x32_bf16 v[120:123], v[48:51], v[28:31], v[120:123]
    ds_read_b128 v[36:39], v5 offset:1024
    v_mfma_f32_16x16x32_bf16 v[124:127], v[52:55], v[28:31], v[124:127]
    ds_read_b128 v[40:43], v5 offset:4096
    v_mfma_f32_16x16x32_bf16 v[116:119], v[52:55], v[24:27], v[116:119]
    ds_read_b128 v[44:47], v5 offset:5120
    v_mfma_f32_16x16x32_bf16 v[108:111], v[52:55], v[20:23], v[108:111]
    ds_read_b64_tr_b16 v[76:77], v7 offset:4096
    v_mfma_f32_16x16x32_bf16 v[100:103], v[52:55], v[16:19], v[100:103]
    ds_read_b64_tr_b16 v[78:79], v7 offset:4608
    v_mfma_f32_16x16x32_bf16 v[128:131], v[56:59], v[16:19], v[128:131]
    ds_read_b64_tr_b16 v[80:81], v6 offset:12288
    v_mfma_f32_16x16x32_bf16 v[136:139], v[56:59], v[20:23], v[136:139]
    ds_read_b64_tr_b16 v[82:83], v6 offset:12800
    v_mfma_f32_16x16x32_bf16 v[144:147], v[56:59], v[24:27], v[144:147]
    ds_read_b64_tr_b16 v[84:85], v7 offset:12288
    v_mfma_f32_16x16x32_bf16 v[152:155], v[56:59], v[28:31], v[152:155]
    ds_read_b64_tr_b16 v[86:87], v7 offset:12800
    v_mfma_f32_16x16x32_bf16 v[156:159], v[60:63], v[28:31], v[156:159]
    ds_read_b64_tr_b16 v[88:89], v6 offset:20480
    v_mfma_f32_16x16x32_bf16 v[148:151], v[60:63], v[24:27], v[148:151]
    ds_read_b64_tr_b16 v[90:91], v6 offset:20992
    v_mfma_f32_16x16x32_bf16 v[140:143], v[60:63], v[20:23], v[140:143]
    ds_read_b64_tr_b16 v[92:93], v7 offset:20480
    v_mfma_f32_16x16x32_bf16 v[132:135], v[60:63], v[16:19], v[132:135]
    ds_read_b64_tr_b16 v[94:95], v7 offset:20992
    v_mfma_f32_16x16x32_bf16 v[160:163], v[16:19], v[64:67], v[160:163]
    s_add_u32 s42, s42, 1
    v_mfma_f32_16x16x32_bf16 v[168:171], v[20:23], v[64:67], v[168:171]
    s_cmp_eq_u32 s42, 3
    v_mfma_f32_16x16x32_bf16 v[176:179], v[24:27], v[64:67], v[176:179]
    s_cselect_b32 s44, 4294885376, s39
    v_mfma_f32_16x16x32_bf16 v[184:187], v[28:31], v[64:67], v[184:187]
    s_cselect_b32 s42, 0, s42
    v_mfma_f32_16x16x32_bf16 v[188:191], v[28:31], v[68:71], v[188:191]
    s_sub_u32 s43, s43, 1
    v_mfma_f32_16x16x32_bf16 v[180:183], v[24:27], v[68:71], v[180:183]
    s_cmp_eq_u32 s43, 0
    v_mfma_f32_16x16x32_bf16 v[172:175], v[20:23], v[68:71], v[172:175]
    v_mfma_f32_16x16x32_bf16 v[164:167], v[16:19], v[68:71], v[164:167]
    s_waitcnt lgkmcnt(0)
    s_barrier
    s_cbranch_scc1 L_clast
    v_mfma_f32_16x16x32_bf16 v[96:99], v[72:75], v[32:35], v[96:99]
    v_add_u32 v6, s44, v6
    v_add_u32 v4, s44, v4
    v_mfma_f32_16x16x32_bf16 v[104:107], v[72:75], v[36:39], v[104:107]
    v_add_u32 v7, s44, v7
    v_mfma_f32_16x16x32_bf16 v[112:115], v[72:75], v[40:43], v[112:115]
    ds_read_b64_tr_b16 v[48:49], v6 offset:0
    v_mfma_f32_16x16x32_bf16 v[120:123], v[72:75], v[44:47], v[120:123]
    ds_read_b64_tr_b16 v[50:51], v6 offset:512
    v_mfma_f32_16x16x32_bf16 v[124:127], v[76:79], v[44:47], v[124:127]
    ds_read_b128 v[16:19], v4 offset:0
    v_mfma_f32_16x16x32_bf16 v[116:119], v[76:79], v[40:43], v[116:119]
    ds_read_b128 v[20:23], v4 offset:1024
    v_mfma_f32_16x16x32_bf16 v[108:111], v[76:79], v[36:39], v[108:111]
    ds_read_b128 v[24:27], v4 offset:4096
    v_mfma_f32_16x16x32_bf16 v[100:103], v[76:79], v[32:35], v[100:103]
    ds_read_b128 v[28:31], v4 offset:5120
    v_mfma_f32_16x16x32_bf16 v[128:131], v[80:83], v[32:35], v[128:131]
    ds_read_b64_tr_b16 v[52:53], v7 offset:0
    v_mfma_f32_16x16x32_bf16 v[136:139], v[80:83], v[36:39], v[136:139]
    ds_read_b64_tr_b16 v[54:55], v7 offset:512
    v_mfma_f32_16x16x32_bf16 v[144:147], v[80:83], v[40:43], v[144:147]
    ds_read_b64_tr_b16 v[56:57], v6 offset:8192
    v_mfma_f32_16x16x32_bf16 v[152:155], v[80:83], v[44:47], v[152:155]
    ds_read_b64_tr_b16 v[58:59], v6 offset:8704
    v_mfma_f32_16x16x32_bf16 v[156:159], v[84:87], v[44:47], v[156:159]
    ds_read_b64_tr_b16 v[60:61], v7 offset:8192
    v_mfma_f32_16x16x32_bf16 v[148:151], v[84:87], v[40:43], v[148:151]
    ds_read_b64_tr_b16 v[62:63], v7 offset:8704
    v_mfma_f32_16x16x32_bf16 v[140:143], v[84:87], v[36:39], v[140:143]
    ds_read_b64_tr_b16 v[64:65], v6 offset:16384
    v_mfma_f32_16x16x32_bf16 v[132:135], v[84:87], v[32:35], v[132:135]
    ds_read_b64_tr_b16 v[66:67], v6 offset:16896
    v_mfma_f32_16x16x32_bf16 v[160:163], v[32:35], v[88:91], v[160:163]
    ds_read_b64_tr_b16 v[68:69], v7 offset:16384
    v_mfma_f32_16x16x32_bf16 v[168:171], v[36:39], v[88:91], v[168:171]
    ds_read_b64_tr_b16 v[70:71], v7 offset:16896
    v_mfma_f32_16x16x32_bf16 v[176:179], v[40:43], v[88:91], v[176:179]
    v_add_u32 v5, s44, v5
    v_mfma_f32_16x16x32_bf16 v[184:187], v[44:47], v[88:91], v[184:187]
    v_mfma_f32_16x16x32_bf16 v[188:191], v[44:47], v[92:95], v[188:191]
    v_mfma_f32_16x16x32_bf16 v[180:183], v[40:43], v[92:95], v[180:183]
    v_mfma_f32_16x16x32_bf16 v[172:175], v[36:39], v[92:95], v[172:175]
    v_mfma_f32_16x16x32_bf16 v[164:167], v[32:35], v[92:95], v[164:167]
    s_branch L_cloop
L_clast:
    v_mfma_f32_16x16x32_bf16 v[96:99], v[72:75], v[32:35], v[96:99]
    v_add_u32 v6, s44, v6
    v_add_u32 v4, s44, v4
    v_mfma_f32_16x16x32_bf16 v[104:107], v[72:75], v[36:39], v[104:107]
    v_add_u32 v7, s44, v7
    v_add_u32 v5, s44, v5
    v_mfma_f32_16x16x32_bf16 v[112:115], v[72:75], v[40:43], v[112:115]
    ds_read_b64_tr_b16 v[48:49], v6 offset:8192
    v_mfma_f32_16x16x32_bf16 v[120:123], v[72:75], v[44:47], v[120:123]
    ds_read_b64_tr_b16 v[50:51], v6 offset:8704
    v_mfma_f32_16x16x32_bf16 v[124:127], v[76:79], v[44:47], v[124:127]
    ds_read_b64_tr_b16 v[52:53], v7 offset:8192
    v_mfma_f32_16x16x32_bf16 v[116:119], v[76:79], v[40:43], v[116:119]
    ds_read_b64_tr_b16 v[54:55], v7 offset:8704
    v_mfma_f32_16x16x32_bf16 v[108:111], v[76:79], v[36:39], v[108:111]
    ds_read_b128 v[192:195], v4 offset:0
    v_mfma_f32_16x16x32_bf16 v[100:103], v[76:79], v[32:35], v[100:103]
    ds_read_b128 v[196:199], v4 offset:1024
    v_mfma_f32_16x16x32_bf16 v[128:131], v[80:83], v[32:35], v[128:131]
    ds_read_b128 v[200:203], v4 offset:4096
    v_mfma_f32_16x16x32_bf16 v[136:139], v[80:83], v[36:39], v[136:139]
    ds_read_b128 v[204:207], v4 offset:5120
    v_mfma_f32_16x16x32_bf16 v[144:147], v[80:83], v[40:43], v[144:147]
    ds_read_b64_tr_b16 v[56:57], v6 offset:12288
    v_mfma_f32_16x16x32_bf16 v[152:155], v[80:83], v[44:47], v[152:155]
    ds_read_b64_tr_b16 v[58:59], v6 offset:12800
    v_mfma_f32_16x16x32_bf16 v[156:159], v[84:87], v[44:47], v[156:159]
    ds_read_b64_tr_b16 v[60:61], v7 offset:12288
    v_mfma_f32_16x16x32_bf16 v[148:151], v[84:87], v[40:43], v[148:151]
    ds_read_b64_tr_b16 v[62:63], v7 offset:12800
    v_mfma_f32_16x16x32_bf16 v[140:143], v[84:87], v[36:39], v[140:143]
    ds_read_b128 v[208:211], v5 offset:0
    v_mfma_f32_16x16x32_bf16 v[132:135], v[84:87], v[32:35], v[132:135]
    ds_read_b128 v[212:215], v5 offset:1024
    v_mfma_f32_16x16x32_bf16 v[160:163], v[32:35], v[88:91], v[160:163]
    ds_read_b128 v[216:219], v5 offset:4096
    v_mfma_f32_16x16x32_bf16 v[168:171], v[36:39], v[88:91], v[168:171]
    ds_read_b128 v[220:223], v5 offset:5120
    v_mfma_f32_16x16x32_bf16 v[176:179], v[40:43], v[88:91], v[176:179]
    v_subrev_u32 v8, 81920, v4
    v_mfma_f32_16x16x32_bf16 v[184:187], v[44:47], v[88:91], v[184:187]
    v_subrev_u32 v9, 81920, v5
    v_mfma_f32_16x16x32_bf16 v[188:191], v[44:47], v[92:95], v[188:191]
    v_subrev_u32 v10, 81920, v6
    v_mfma_f32_16x16x32_bf16 v[180:183], v[40:43], v[92:95], v[180:183]
    v_subrev_u32 v11, 81920, v7
    v_mfma_f32_16x16x32_bf16 v[172:175], v[36:39], v[92:95], v[172:175]
    v_mfma_f32_16x16x32_bf16 v[164:167], v[32:35], v[92:95], v[164:167]
    s_waitcnt lgkmcnt(8)
    s_barrier
    v_mfma_f32_16x16x32_bf16 v[128:131], v[48:51], v[192:195], v[128:131]
    ds_read_b64_tr_b16 v[64:65], v10 offset:8192
    v_mfma_f32_16x16x32_bf16 v[136:139], v[48:51], v[196:199], v[136:139]
    ds_read_b64_tr_b16 v[66:67], v10 offset:8704
    v_mfma_f32_16x16x32_bf16 v[144:147], v[48:51], v[200:203], v[144:147]
    ds_read_b64_tr_b16 v[68:69], v11 offset:8192
    v_mfma_f32_16x16x32_bf16 v[152:155], v[48:51], v[204:207], v[152:155]
    ds_read_b64_tr_b16 v[70:71], v11 offset:8704
    v_mfma_f32_16x16x32_bf16 v[132:135], v[52:55], v[192:195], v[132:135]
    ds_read_b128 v[16:19], v8 offset:0
    v_mfma_f32_16x16x32_bf16 v[140:143], v[52:55], v[196:199], v[140:143]
    ds_read_b128 v[20:23], v8 offset:1024
    v_mfma_f32_16x16x32_bf16 v[148:151], v[52:55], v[200:203], v[148:151]
    ds_read_b128 v[24:27], v8 offset:4096
    v_mfma_f32_16x16x32_bf16 v[156:159], v[52:55], v[204:207], v[156:159]
    ds_read_b128 v[28:31], v8 offset:5120
    s_waitcnt lgkmcnt(8)
    v_mfma_f32_16x16x32_bf16 v[128:131], v[56:59], v[208:211], v[128:131]
    ds_read_b64_tr_b16 v[72:73], v10 offset:12288
    v_mfma_f32_16x16x32_bf16 v[136:139], v[56:59], v[212:215], v[136:139]
    ds_read_b64_tr_b16 v[74:75], v10 offset:12800
    v_mfma_f32_16x16x32_bf16 v[144:147], v[56:59], v[216:219], v[144:147]
    ds_read_b64_tr_b16 v[76:77], v11 offset:12288
    v_mfma_f32_16x16x32_bf16 v[152:155], v[56:59], v[220:223], v[152:155]
    ds_read_b64_tr_b16 v[78:79], v11 offset:12800
    v_mfma_f32_16x16x32_bf16 v[132:135], v[60:63], v[208:211], v[132:135]
    ds_read_b128 v[32:35], v9 offset:0
    v_mfma_f32_16x16x32_bf16 v[140:143], v[60:63], v[212:215], v[140:143]
    ds_read_b128 v[36:39], v9 offset:1024
    v_mfma_f32_16x16x32_bf16 v[148:151], v[60:63], v[216:219], v[148:151]
    ds_read_b128 v[40:43], v9 offset:4096
    v_mfma_f32_16x16x32_bf16 v[156:159], v[60:63], v[220:223], v[156:159]
    ds_read_b128 v[44:47], v9 offset:5120
    s_waitcnt lgkmcnt(8)
    v_mfma_f32_16x16x32_bf16 v[128:131], v[64:67], v[16:19], v[128:131]
    ds_read_b64_tr_b16 v[80:81], v6 offset:16384
    v_mfma_f32_16x16x32_bf16 v[136:139], v[64:67], v[20:23], v[136:139]
    ds_read_b64_tr_b16 v[82:83], v6 offset:16896
    v_mfma_f32_16x16x32_bf16 v[144:147], v[64:67], v[24:27], v[144:147]
    ds_read_b64_tr_b16 v[84:85], v7 offset:16384
    v_mfma_f32_16x16x32_bf16 v[152:155], v[64:67], v[28:31], v[152:155]
    ds_read_b64_tr_b16 v[86:87], v7 offset:16896
    v_mfma_f32_16x16x32_bf16 v[132:135], v[68:71], v[16:19], v[132:135]
    ds_read_b64_tr_b16 v[88:89], v6 offset:20480
    v_mfma_f32_16x16x32_bf16 v[140:143], v[68:71], v[20:23], v[140:143]
    ds_read_b64_tr_b16 v[90:91], v6 offset:20992
    v_mfma_f32_16x16x32_bf16 v[148:151], v[68:71], v[24:27], v[148:151]
    ds_read_b64_tr_b16 v[92:93], v7 offset:20480
    v_mfma_f32_16x16x32_bf16 v[156:159], v[68:71], v[28:31], v[156:159]
    ds_read_b64_tr_b16 v[94:95], v7 offset:20992
    s_waitcnt lgkmcnt(8)
    v_mfma_f32_16x16x32_bf16 v[128:131], v[72:75], v[32:35], v[128:131]
    ds_read_b64_tr_b16 v[48:49], v10 offset:16384
    v_mfma_f32_16x16x32_bf16 v[136:139], v[72:75], v[36:39], v[136:139]
    ds_read_b64_tr_b16 v[50:51], v10 offset:16896
    v_mfma_f32_16x16x32_bf16 v[144:147], v[72:75], v[40:43], v[144:147]
    ds_read_b64_tr_b16 v[52:53], v11 offset:16384
    v_mfma_f32_16x16x32_bf16 v[152:155], v[72:75], v[44:47], v[152:155]
    ds_read_b64_tr_b16 v[54:55], v11 offset:16896
    v_mfma_f32_16x16x32_bf16 v[132:135], v[76:79], v[32:35], v[132:135]
    v_mfma_f32_16x16x32_bf16 v[140:143], v[76:79], v[36:39], v[140:143]
    v_mfma_f32_16x16x32_bf16 v[148:151], v[76:79], v[40:43], v[148:151]
    v_mfma_f32_16x16x32_bf16 v[156:159], v[76:79], v[44:47], v[156:159]
    s_waitcnt lgkmcnt(8)
    v_mfma_f32_16x16x32_bf16 v[160:163], v[192:195], v[80:83], v[160:163]
    ds_read_b64_tr_b16 v[56:57], v10 offset:20480
    ds_read_b64_tr_b16 v[58:59], v10 offset:20992
    v_mfma_f32_16x16x32_bf16 v[168:171], v[196:199], v[80:83], v[168:171]
    ds_read_b64_tr_b16 v[60:61], v11 offset:20480
    ds_read_b64_tr_b16 v[62:63], v11 offset:20992
    v_mfma_f32_16x16x32_bf16 v[176:179], v[200:203], v[80:83], v[176:179]
    v_cvt_pk_bf16_f32 v224, v128, v129
    v_cvt_pk_bf16_f32 v225, v130, v131
    v_mfma_f32_16x16x32_bf16 v[184:187], v[204:207], v[80:83], v[184:187]
    v_cvt_pk_bf16_f32 v226, v132, v133
    v_cvt_pk_bf16_f32 v227, v134, v135
    v_mfma_f32_16x16x32_bf16 v[164:167], v[192:195], v[84:87], v[164:167]
    buffer_store_dwordx4 v[224:227], v14, s[12:15], s48 offen offset:0 sc1
    v_cvt_pk_bf16_f32 v228, v136, v137
    v_mfma_f32_16x16x32_bf16 v[172:175], v[196:199], v[84:87], v[172:175]
    v_cvt_pk_bf16_f32 v229, v138, v139
    v_cvt_pk_bf16_f32 v230, v140, v141
    v_mfma_f32_16x16x32_bf16 v[180:183], v[200:203], v[84:87], v[180:183]
    v_cvt_pk_bf16_f32 v231, v142, v143
    buffer_store_dwordx4 v[228:231], v14, s[12:15], s48 offen offset:128 sc1
    v_mfma_f32_16x16x32_bf16 v[188:191], v[204:207], v[84:87], v[188:191]
    s_waitcnt lgkmcnt(8)
    v_mfma_f32_16x16x32_bf16 v[160:163], v[208:211], v[88:91], v[160:163]
    ds_read_b64_tr_b16 v[64:65], v6 offset:0
    v_cvt_pk_bf16_f32 v232, v144, v145
    v_mfma_f32_16x16x32_bf16 v[168:171], v[212:215], v[88:91], v[168:171]
    v_cvt_pk_bf16_f32 v233, v146, v147
    ds_read_b64_tr_b16 v[66:67], v6 offset:512
    v_mfma_f32_16x16x32_bf16 v[176:179], v[216:219], v[88:91], v[176:179]
    v_cvt_pk_bf16_f32 v234, v148, v149
    v_cvt_pk_bf16_f32 v235, v150, v151
    v_mfma_f32_16x16x32_bf16 v[184:187], v[220:223], v[88:91], v[184:187]
    ds_read_b64_tr_b16 v[68:69], v7 offset:0
    buffer_store_dwordx4 v[232:235], v14, s[12:15], s49 offen offset:0 sc1
    v_mfma_f32_16x16x32_bf16 v[164:167], v[208:211], v[92:95], v[164:167]
    v_cvt_pk_bf16_f32 v236, v152, v153
    ds_read_b64_tr_b16 v[70:71], v7 offset:512
    v_mfma_f32_16x16x32_bf16 v[172:175], v[212:215], v[92:95], v[172:175]
    v_cvt_pk_bf16_f32 v237, v154, v155
    v_cvt_pk_bf16_f32 v238, v156, v157
    v_mfma_f32_16x16x32_bf16 v[180:183], v[216:219], v[92:95], v[180:183]
    v_cvt_pk_bf16_f32 v239, v158, v159
    buffer_store_dwordx4 v[236:239], v14, s[12:15], s49 offen offset:128 sc1
    v_mfma_f32_16x16x32_bf16 v[188:191], v[220:223], v[92:95], v[188:191]
    s_waitcnt lgkmcnt(8)
    v_mfma_f32_16x16x32_bf16 v[160:163], v[16:19], v[48:51], v[160:163]
    ds_read_b64_tr_b16 v[72:73], v6 offset:4096
    v_mfma_f32_16x16x32_bf16 v[168:171], v[20:23], v[48:51], v[168:171]
    ds_read_b64_tr_b16 v[74:75], v6 offset:4608
    v_mfma_f32_16x16x32_bf16 v[176:179], v[24:27], v[48:51], v[176:179]
    ds_read_b64_tr_b16 v[76:77], v7 offset:4096
    v_mfma_f32_16x16x32_bf16 v[184:187], v[28:31], v[48:51], v[184:187]
    ds_read_b64_tr_b16 v[78:79], v7 offset:4608
    v_mfma_f32_16x16x32_bf16 v[164:167], v[16:19], v[52:55], v[164:167]
    v_mfma_f32_16x16x32_bf16 v[172:175], v[20:23], v[52:55], v[172:175]
    v_mfma_f32_16x16x32_bf16 v[180:183], v[24:27], v[52:55], v[180:183]
    v_mfma_f32_16x16x32_bf16 v[188:191], v[28:31], v[52:55], v[188:191]
    s_waitcnt lgkmcnt(8)
    v_mfma_f32_16x16x32_bf16 v[160:163], v[32:35], v[56:59], v[160:163]
    ds_read_b64_tr_b16 v[80:81], v10 offset:0
    v_mfma_f32_16x16x32_bf16 v[168:171], v[36:39], v[56:59], v[168:171]
    s_mov_b32 s44, 1048744942
    v_mfma_f32_16x16x32_bf16 v[176:179], v[40:43], v[56:59], v[176:179]
    ds_read_b64_tr_b16 v[82:83], v10 offset:512
    v_mfma_f32_16x16x32_bf16 v[184:187], v[44:47], v[56:59], v[184:187]
    s_mov_b32 s45, s44
    v_mfma_f32_16x16x32_bf16 v[164:167], v[32:35], v[60:63], v[164:167]
    ds_read_b64_tr_b16 v[84:85], v11 offset:0
    v_mfma_f32_16x16x32_bf16 v[172:175], v[36:39], v[60:63], v[172:175]
    ds_read_b64_tr_b16 v[86:87], v11 offset:512
    v_mfma_f32_16x16x32_bf16 v[180:183], v[40:43], v[60:63], v[180:183]
    v_mfma_f32_16x16x32_bf16 v[188:191], v[44:47], v[60:63], v[188:191]
    s_waitcnt lgkmcnt(8)
    v_mfma_f32_16x16x32_bf16 v[96:99], v[64:67], v[192:195], v[96:99]
    ds_read_b64_tr_b16 v[88:89], v10 offset:4096
    ds_read_b64_tr_b16 v[90:91], v10 offset:4608
    v_mfma_f32_16x16x32_bf16 v[104:107], v[64:67], v[196:199], v[104:107]
    ds_read_b64_tr_b16 v[92:93], v11 offset:4096
    ds_read_b64_tr_b16 v[94:95], v11 offset:4608
    v_mfma_f32_16x16x32_bf16 v[112:115], v[64:67], v[200:203], v[112:115]
    v_cvt_pk_bf16_f32 v240, v160, v161
    v_cvt_pk_bf16_f32 v241, v162, v163
    v_mfma_f32_16x16x32_bf16 v[120:123], v[64:67], v[204:207], v[120:123]
    v_cvt_pk_bf16_f32 v242, v168, v169
    v_cvt_pk_bf16_f32 v243, v170, v171
    v_mfma_f32_16x16x32_bf16 v[100:103], v[68:71], v[192:195], v[100:103]
    v_cvt_pk_bf16_f32 v244, v176, v177
    v_cvt_pk_bf16_f32 v245, v178, v179
    v_mfma_f32_16x16x32_bf16 v[108:111], v[68:71], v[196:199], v[108:111]
    v_cvt_pk_bf16_f32 v246, v184, v185
    v_cvt_pk_bf16_f32 v247, v186, v187
    v_mfma_f32_16x16x32_bf16 v[116:119], v[68:71], v[200:203], v[116:119]
    v_cvt_pk_bf16_f32 v248, v164, v165
    v_cvt_pk_bf16_f32 v249, v166, v167
    v_mfma_f32_16x16x32_bf16 v[124:127], v[68:71], v[204:207], v[124:127]
    s_waitcnt lgkmcnt(8)
    v_mfma_f32_16x16x32_bf16 v[96:99], v[72:75], v[208:211], v[96:99]
    v_cvt_pk_bf16_f32 v250, v172, v173
    v_mfma_f32_16x16x32_bf16 v[104:107], v[72:75], v[212:215], v[104:107]
    v_cvt_pk_bf16_f32 v251, v174, v175
    v_mfma_f32_16x16x32_bf16 v[112:115], v[72:75], v[216:219], v[112:115]
    v_cvt_pk_bf16_f32 v252, v180, v181
    v_mfma_f32_16x16x32_bf16 v[120:123], v[72:75], v[220:223], v[120:123]
    v_cvt_pk_bf16_f32 v253, v182, v183
    v_mfma_f32_16x16x32_bf16 v[100:103], v[76:79], v[208:211], v[100:103]
    v_cvt_pk_bf16_f32 v254, v188, v189
    v_mfma_f32_16x16x32_bf16 v[108:111], v[76:79], v[212:215], v[108:111]
    v_cvt_pk_bf16_f32 v255, v190, v191
    v_mfma_f32_16x16x32_bf16 v[116:119], v[76:79], v[216:219], v[116:119]
    v_mfma_f32_16x16x32_bf16 v[124:127], v[76:79], v[220:223], v[124:127]
    s_waitcnt lgkmcnt(4)
    v_mfma_f32_16x16x32_bf16 v[96:99], v[80:83], v[16:19], v[96:99]
    ds_read_b128 v[192:195], v3 offset:0
    v_mfma_f32_16x16x32_bf16 v[104:107], v[80:83], v[20:23], v[104:107]
    v_add_u32 v10, s52, v14
    v_mfma_f32_16x16x32_bf16 v[112:115], v[80:83], v[24:27], v[112:115]
    ds_read_b128 v[196:199], v3 offset:1024
    v_mfma_f32_16x16x32_bf16 v[120:123], v[80:83], v[28:31], v[120:123]
    v_add_u32 v11, s53, v15
    v_mfma_f32_16x16x32_bf16 v[100:103], v[84:87], v[16:19], v[100:103]
    ds_read_b128 v[200:203], v3 offset:2048
    v_mfma_f32_16x16x32_bf16 v[108:111], v[84:87], v[20:23], v[108:111]
    v_add_u32 v13, s40, v14
    v_mfma_f32_16x16x32_bf16 v[116:119], v[84:87], v[24:27], v[116:119]
    ds_read_b128 v[204:207], v3 offset:3072
    v_mfma_f32_16x16x32_bf16 v[124:127], v[84:87], v[28:31], v[124:127]
    s_waitcnt lgkmcnt(4)
    v_mfma_f32_16x16x32_bf16 v[96:99], v[88:91], v[32:35], v[96:99]
    ds_read_b128 v[208:211], v3 offset:4096
    v_mfma_f32_16x16x32_bf16 v[104:107], v[88:91], v[36:39], v[104:107]
    v_lshlrev_b32 v8, 2, v1
    v_mfma_f32_16x16x32_bf16 v[112:115], v[88:91], v[40:43], v[112:115]
    ds_read_b128 v[212:215], v3 offset:5120
    v_mfma_f32_16x16x32_bf16 v[120:123], v[88:91], v[44:47], v[120:123]
    v_add_u32 v8, s32, v8
    v_mfma_f32_16x16x32_bf16 v[100:103], v[92:95], v[32:35], v[100:103]
    ds_read_b128 v[216:219], v3 offset:6144
    v_mfma_f32_16x16x32_bf16 v[108:111], v[92:95], v[36:39], v[108:111]
    v_lshlrev_b32_e64 v8, v8, 1
    v_mfma_f32_16x16x32_bf16 v[116:119], v[92:95], v[40:43], v[116:119]
    ds_read_b128 v[220:223], v3 offset:7168
    v_mfma_f32_16x16x32_bf16 v[124:127], v[92:95], v[44:47], v[124:127]
    v_lshlrev_b32 v9, 11, v1
    s_waitcnt vmcnt(0)
    s_cmp_eq_u32 s47, 0
    s_cbranch_scc1 L_nosig
    s_mov_b32 exec_lo, s47
    s_mov_b32 exec_hi, 0
    buffer_atomic_or v8, v9, s[12:15], s46 offen sc1
    s_mov_b64 exec, -1
L_nosig:
    buffer_store_dwordx4 v[240:243], v15, s[12:15], s50 offen offset:0 sc1
    buffer_store_dwordx4 v[244:247], v15, s[12:15], s51 offen offset:0 sc1
    buffer_store_dwordx4 v[248:251], v15, s[12:15], s50 offen offset:256 sc1
    buffer_store_dwordx4 v[252:255], v15, s[12:15], s51 offen offset:256 sc1
    v_pk_mul_f32 v[96:97], v[96:97], s[44:45]
    v_pk_mul_f32 v[98:99], v[98:99], s[44:45]
    v_pk_mul_f32 v[100:101], v[100:101], s[44:45]
    v_pk_mul_f32 v[102:103], v[102:103], s[44:45]
    v_pk_mul_f32 v[104:105], v[104:105], s[44:45]
    v_pk_mul_f32 v[106:107], v[106:107], s[44:45]
    v_pk_mul_f32 v[108:109], v[108:109], s[44:45]
    v_pk_mul_f32 v[110:111], v[110:111], s[44:45]
    v_pk_mul_f32 v[112:113], v[112:113], s[44:45]
    v_pk_mul_f32 v[114:115], v[114:115], s[44:45]
    v_pk_mul_f32 v[116:117], v[116:117], s[44:45]
    v_pk_mul_f32 v[118:119], v[118:119], s[44:45]
    v_pk_mul_f32 v[120:121], v[120:121], s[44:45]
    v_pk_mul_f32 v[122:123], v[122:123], s[44:45]
    v_pk_mul_f32 v[124:125], v[124:125], s[44:45]
    v_pk_mul_f32 v[126:127], v[126:127], s[44:45]
    v_cvt_pk_bf16_f32 v64, v96, v97
    v_cvt_pk_bf16_f32 v65, v98, v99
    v_cvt_pk_bf16_f32 v66, v100, v101
    v_cvt_pk_bf16_f32 v67, v102, v103
    v_cvt_pk_bf16_f32 v68, v104, v105
    v_cvt_pk_bf16_f32 v69, v106, v107
    v_cvt_pk_bf16_f32 v70, v108, v109
    v_cvt_pk_bf16_f32 v71, v110, v111
    v_cvt_pk_bf16_f32 v72, v112, v113
    v_cvt_pk_bf16_f32 v73, v114, v115
    v_cvt_pk_bf16_f32 v74, v116, v117
    v_cvt_pk_bf16_f32 v75, v118, v119
    v_cvt_pk_bf16_f32 v76, v120, v121
    v_cvt_pk_bf16_f32 v77, v122, v123
    v_cvt_pk_bf16_f32 v78, v124, v125
    v_cvt_pk_bf16_f32 v79, v126, v127
    s_waitcnt lgkmcnt(0)
    s_barrier
    v_lshlrev_b32 v8, 8, v8
L_join:
    s_lshl_b32 s36, s32, 5
    s_and_b32 s36, s36, 0x70
    s_lshl_b32 s37, s32, 12
    s_add_u32 s37, s37, 49152
    v_xor_b32 v4, s36, v216
    v_add_u32 v4, s37, v4
    v_xor_b32 v5, 16, v4
    v_add_u32 v6, 149504, v2
    ds_read_b64_tr_b16 v[16:17], v4 offset:0
    ds_read_b64_tr_b16 v[18:19], v4 offset:512
    ds_read_b64_tr_b16 v[20:21], v4 offset:1024
    ds_read_b64_tr_b16 v[22:23], v4 offset:1536
    ds_read_b128 v[128:131], v6 offset:0
    ds_read_b128 v[132:135], v6 offset:1024
    ds_read_b128 v[136:139], v6 offset:2048
    ds_read_b128 v[140:143], v6 offset:3072
    ds_read_b64_tr_b16 v[24:25], v5 offset:2048
    ds_read_b64_tr_b16 v[26:27], v5 offset:2560
    ds_read_b64_tr_b16 v[28:29], v5 offset:3072
    ds_read_b64_tr_b16 v[30:31], v5 offset:3584
    ds_read_b128 v[144:147], v6 offset:4096
    ds_read_b128 v[148:151], v6 offset:5120
    s_mov_b32 s44, 4048155338
    s_mov_b32 s45, s44
    v_pk_add_f32 v[96:97], s[44:45], v[192:193] neg_lo:[0,1] neg_hi:[0,1]
    v_pk_add_f32 v[98:99], s[44:45], v[194:195] neg_lo:[0,1] neg_hi:[0,1]
    v_pk_add_f32 v[100:101], s[44:45], v[196:197] neg_lo:[0,1] neg_hi:[0,1]
    v_pk_add_f32 v[102:103], s[44:45], v[198:199] neg_lo:[0,1] neg_hi:[0,1]
    v_pk_add_f32 v[104:105], s[44:45], v[200:201] neg_lo:[0,1] neg_hi:[0,1]
    v_pk_add_f32 v[106:107], s[44:45], v[202:203] neg_lo:[0,1] neg_hi:[0,1]
    v_pk_add_f32 v[108:109], s[44:45], v[204:205] neg_lo:[0,1] neg_hi:[0,1]
    v_pk_add_f32 v[110:111], s[44:45], v[206:207] neg_lo:[0,1] neg_hi:[0,1]
    s_waitcnt lgkmcnt(6)
    v_mfma_f32_32x32x16_bf16 v[32:47], v[16:19], v[128:131], 0
    ds_read_b128 v[152:155], v6 offset:6144
    ds_read_b128 v[156:159], v6 offset:7168
    v_mfma_f32_32x32x16_bf16 v[48:63], v[16:19], v[136:139], 0
    ds_read_b128 v[160:163], v6 offset:8192
    ds_read_b128 v[164:167], v6 offset:9216
    v_mfma_f32_32x32x16_bf16 v[32:47], v[20:23], v[132:135], v[32:47]
    ds_read_b128 v[168:171], v6 offset:10240
    ds_read_b128 v[172:175], v6 offset:11264
    v_mfma_f32_32x32x16_bf16 v[48:63], v[20:23], v[140:143], v[48:63]
    ds_read_b128 v[176:179], v6 offset:12288
    ds_read_b128 v[180:183], v6 offset:13312
    s_waitcnt lgkmcnt(8)
    v_mfma_f32_32x32x16_bf16 v[32:47], v[24:27], v[144:147], v[32:47]
    v_mfma_f32_32x32x16_bf16 v[32:47], v[28:31], v[148:151], v[32:47]
    v_mfma_f32_32x32x16_bf16 v[48:63], v[24:27], v[128:131], v[48:63]
    v_mfma_f32_32x32x16_bf16 v[48:63], v[28:31], v[132:135], v[48:63]
    s_lshl_b32 s36, s32, 11
    v_add_u32 v6, s36, v2
    v_add_u32 v4, 81920, v6
    v_add_u32 v5, 131072, v6
    s_waitcnt lgkmcnt(0)
    s_cmp_lt_u32 s32, 4
    s_cbranch_scc1 L_sig2
    s_cmp_ge_u32 s33, 2
    s_cselect_b32 s36, 0, 0x20000000
    s_cselect_b32 s38, 17, 1
    v_add_u32 v12, s36, v2
    s_cmp_ge_u32 s33, 1
    s_cselect_b32 s36, 0, 0x20000000
    s_cselect_b32 s38, s38, 0
    v_add_u32 v13, s36, v2
    s_add_u32 s37, s32, 4294967292
    s_lshl_b32 s38, s38, s37
    s_mov_b32 s61, 262144
L_nbp_3:
    s_waitcnt vmcnt(0)
    v_readfirstlane_b32 s36, v15
    s_nop 0
    s_andn2_b32 s36, s38, s36
    s_cbranch_scc0 L_nbgo_4
    v_mov_b32 v15, 0
    s_mov_b64 exec, 1
    buffer_atomic_or v15, v2, s[12:15], s23 offen sc0 sc1
    s_mov_b64 exec, -1
    s_sub_u32 s61, s61, 1
    s_cmp_lg_u32 s61, 0
    s_cbranch_scc1 L_nbp_3
L_nbgo_4:
    s_add_u32 m0, s20, 98304
    s_add_u32 s48, s22, 0
    buffer_load_dwordx4 v13, s[12:15], s48 offen offset:0 sc1 lds
    buffer_load_dwordx4 v13, s[12:15], s48 offen offset:1024 sc1 lds
    s_add_u32 m0, s20, 102400
    s_add_u32 s48, s22, 4096
    buffer_load_dwordx4 v13, s[12:15], s48 offen offset:0 sc1 lds
    buffer_load_dwordx4 v13, s[12:15], s48 offen offset:1024 sc1 lds
    s_add_u32 m0, s20, 81920
    s_add_u32 s48, s21, 0
    buffer_load_dwordx4 v12, s[12:15], s48 offen offset:0 sc1 lds
    buffer_load_dwordx4 v12, s[12:15], s48 offen offset:1024 sc1 lds
    s_add_u32 m0, s20, 86016
    s_add_u32 s48, s21, 4096
    buffer_load_dwordx4 v12, s[12:15], s48 offen offset:0 sc1 lds
    buffer_load_dwordx4 v12, s[12:15], s48 offen offset:1024 sc1 lds
    s_branch L_nosig2
L_sig2:
    ds_write_b128 v10, v[224:227] offset:0
    ds_write_b128 v10, v[228:231] offset:128
    ds_write_b128 v10, v[232:235] offset:4096
    ds_write_b128 v10, v[236:239] offset:4224
    s_waitcnt vmcnt(0)
    s_cmp_eq_u32 s47, 0
    s_cbranch_scc1 L_sig3
    s_mov_b32 exec_lo, s47
    s_mov_b32 exec_hi, 0
    buffer_atomic_or v8, v9, s[12:15], s46 offen sc1
    s_mov_b64 exec, -1
L_sig3:
    ds_write_b128 v11, v[240:243] offset:0
    ds_write_b128 v11, v[244:247] offset:4096
    ds_write_b128 v11, v[248:251] offset:256
    ds_write_b128 v11, v[252:255] offset:4352
    ds_write_b128 v13, v[64:67] offset:0
    ds_write_b128 v13, v[68:71] offset:128
    ds_write_b128 v13, v[72:75] offset:4096
    ds_write_b128 v13, v[76:79] offset:4224
L_nosig2:
    s_nop 7
    v_pk_mul_f32 v[80:81], v[32:33], v[152:153]
    v_pk_mul_f32 v[112:113], v[32:33], v[168:169]
    v_pk_mul_f32 v[82:83], v[34:35], v[154:155]
    v_pk_mul_f32 v[114:115], v[34:35], v[170:171]
    v_pk_mul_f32 v[84:85], v[36:37], v[156:157]
    v_pk_mul_f32 v[116:117], v[36:37], v[172:173]
    v_pk_mul_f32 v[86:87], v[38:39], v[158:159]
    v_pk_mul_f32 v[118:119], v[38:39], v[174:175]
    v_pk_mul_f32 v[88:89], v[40:41], v[160:161]
    v_pk_mul_f32 v[120:121], v[40:41], v[176:177]
    v_pk_mul_f32 v[90:91], v[42:43], v[162:163]
    v_pk_mul_f32 v[122:123], v[42:43], v[178:179]
    v_pk_mul_f32 v[92:93], v[44:45], v[164:165]
    v_pk_mul_f32 v[124:125], v[44:45], v[180:181]
    v_pk_mul_f32 v[94:95], v[46:47], v[166:167]
    v_pk_mul_f32 v[126:127], v[46:47], v[182:183]
    v_pk_fma_f32 v[80:81], v[48:49], v[168:169], v[80:81] neg_lo:[1,0,0] neg_hi:[1,0,0]
    v_pk_fma_f32 v[82:83], v[50:51], v[170:171], v[82:83] neg_lo:[1,0,0] neg_hi:[1,0,0]
    v_pk_fma_f32 v[84:85], v[52:53], v[172:173], v[84:85] neg_lo:[1,0,0] neg_hi:[1,0,0]
    v_pk_fma_f32 v[86:87], v[54:55], v[174:175], v[86:87] neg_lo:[1,0,0] neg_hi:[1,0,0]
    v_pk_fma_f32 v[88:89], v[56:57], v[176:177], v[88:89] neg_lo:[1,0,0] neg_hi:[1,0,0]
    v_pk_fma_f32 v[90:91], v[58:59], v[178:179], v[90:91] neg_lo:[1,0,0] neg_hi:[1,0,0]
    v_pk_fma_f32 v[92:93], v[60:61], v[180:181], v[92:93] neg_lo:[1,0,0] neg_hi:[1,0,0]
    v_pk_fma_f32 v[94:95], v[62:63], v[182:183], v[94:95] neg_lo:[1,0,0] neg_hi:[1,0,0]
    v_cvt_pk_bf16_f32 v16, v80, v81
    v_cvt_pk_bf16_f32 v17, v82, v83
    v_cvt_pk_bf16_f32 v18, v84, v85
    v_cvt_pk_bf16_f32 v19, v86, v87
    v_cvt_pk_bf16_f32 v20, v88, v89
    v_cvt_pk_bf16_f32 v21, v90, v91
    v_cvt_pk_bf16_f32 v22, v92, v93
    v_cvt_pk_bf16_f32 v23, v94, v95
    v_pk_fma_f32 v[112:113], v[48:49], v[152:153], v[112:113]
    v_pk_fma_f32 v[114:115], v[50:51], v[154:155], v[114:115]
    v_mfma_f32_32x32x16_bf16 v[32:47], v[16:19], v[128:131], 0
    v_pk_fma_f32 v[116:117], v[52:53], v[156:157], v[116:117]
    v_pk_fma_f32 v[118:119], v[54:55], v[158:159], v[118:119]
    v_pk_fma_f32 v[120:121], v[56:57], v[160:161], v[120:121]
    v_pk_fma_f32 v[122:123], v[58:59], v[162:163], v[122:123]
    v_pk_fma_f32 v[124:125], v[60:61], v[164:165], v[124:125]
    v_pk_fma_f32 v[126:127], v[62:63], v[166:167], v[126:127]
    v_mfma_f32_32x32x16_bf16 v[32:47], v[20:23], v[132:135], v[32:47]
    v_cvt_pk_bf16_f32 v24, v112, v113
    v_cvt_pk_bf16_f32 v25, v114, v115
    v_cvt_pk_bf16_f32 v26, v116, v117
    v_cvt_pk_bf16_f32 v27, v118, v119
    v_cvt_pk_bf16_f32 v28, v120, v121
    v_cvt_pk_bf16_f32 v29, v122, v123
    v_cvt_pk_bf16_f32 v30, v124, v125
    v_cvt_pk_bf16_f32 v31, v126, v127
    v_mov_b32 v89, 0
    v_mov_b32 v90, 0
    v_mov_b32 v91, 0
    v_mfma_f32_32x32x16_bf16 v[32:47], v[24:27], v[144:147], v[32:47]
    v_mfma_f32_32x32x16_bf16 v[32:47], v[28:31], v[148:151], v[32:47]
    v_mov_b32 v12, 0x3f803f80
    v_mov_b32 v13, 0x3f803f80
    v_mov_b32 v14, 0x3f803f80
    v_mov_b32 v15, 0x3f803f80
    v_lshrrev_b32 v8, 2, v1
    v_lshrrev_b32 v9, 4, v1
    v_xor_b32 v8, v8, v9
    v_and_b32 v8, 1, v8
    v_subrev_u32 v8, 1, v8
    v_and_b32 v8, 0x3f803f80, v8
    v_mov_b32 v9, v8
    v_mov_b32 v10, v8
    v_mov_b32 v11, v8
    s_cmp_lt_u32 s32, 4
    s_cbranch_scc1 L_nopk
    v_mov_b32 v7, 0
    s_mov_b64 exec, 1
    buffer_atomic_or v7, v2, s[12:15], s23 offen sc0 sc1
    s_mov_b64 exec, -1
L_nopk:
    v_cvt_pk_bf16_f32 v64, v32, v33
    v_cvt_pk_bf16_f32 v65, v34, v35
    v_cvt_pk_bf16_f32 v66, v36, v37
    v_cvt_pk_bf16_f32 v67, v38, v39
    v_cvt_pk_bf16_f32 v68, v40, v41
    v_cvt_pk_bf16_f32 v69, v42, v43
    v_cvt_pk_bf16_f32 v70, v44, v45
    v_cvt_pk_bf16_f32 v71, v46, v47
    v_permlane32_swap_b32 v64, v66
    v_permlane32_swap_b32 v65, v67
    v_permlane32_swap_b32 v68, v70
    v_permlane32_swap_b32 v69, v71
    s_nop 0
    v_permlane16_swap_b32 v64, v68
    v_permlane16_swap_b32 v65, v69
    v_permlane16_swap_b32 v66, v70
    v_permlane16_swap_b32 v67, v71
    s_cmp_lt_u32 s32, 4
    s_cbranch_scc1 L_e2o
    s_setprio 0
    s_waitcnt vmcnt(1)
L_e2o:
    s_waitcnt lgkmcnt(0)
    s_barrier
    s_cmp_lt_u32 s32, 4
    s_cbranch_scc1 L_now1
    s_cmp_ge_u32 s33, 2
    s_cselect_b32 s36, 0, 0x20000000
    s_cselect_b32 s38, 17, 1
    v_add_u32 v16, s36, v2
    s_cmp_ge_u32 s33, 1
    s_cselect_b32 s36, 0, 0x20000000
    s_cselect_b32 s38, s38, 0
    v_add_u32 v17, s36, v2
    s_add_u32 s37, s32, 4
    s_lshl_b32 s38, s38, s37
    s_mov_b32 s61, 262144
L_nbp_5:
    s_waitcnt vmcnt(0)
    v_readfirstlane_b32 s36, v7
    s_nop 0
    s_andn2_b32 s36, s38, s36
    s_cbranch_scc0 L_nbgo_6
    v_mov_b32 v7, 0
    s_mov_b64 exec, 1
    buffer_atomic_or v7, v2, s[12:15], s23 offen sc0 sc1
    s_mov_b64 exec, -1
    s_sub_u32 s61, s61, 1
    s_cmp_lg_u32 s61, 0
    s_cbranch_scc1 L_nbp_5
L_nbgo_6:
    s_add_u32 m0, s20, 16384
    s_add_u32 s48, s22, 4194304
    buffer_load_dwordx4 v17, s[12:15], s48 offen offset:0 sc1 lds
    buffer_load_dwordx4 v17, s[12:15], s48 offen offset:1024 sc1 lds
    s_add_u32 m0, s20, 20480
    s_add_u32 s48, s22, 4198400
    buffer_load_dwordx4 v17, s[12:15], s48 offen offset:0 sc1 lds
    buffer_load_dwordx4 v17, s[12:15], s48 offen offset:1024 sc1 lds
    s_add_u32 m0, s20, 0
    s_add_u32 s48, s21, 4194304
    buffer_load_dwordx4 v16, s[12:15], s48 offen offset:0 sc1 lds
    buffer_load_dwordx4 v16, s[12:15], s48 offen offset:1024 sc1 lds
    s_add_u32 m0, s20, 4096
    s_add_u32 s48, s21, 4198400
    buffer_load_dwordx4 v16, s[12:15], s48 offen offset:0 sc1 lds
    buffer_load_dwordx4 v16, s[12:15], s48 offen offset:1024 sc1 lds
L_now1:
    ds_read_b128 v[72:75], v5
    ds_read_b128 v[76:79], v5 offset:1024
    s_cmp_lg_u32 s54, 0
    s_cbranch_scc1 L_qkslow
    ds_read_b128 v[16:19], v4 offset:32768
    ds_read_b128 v[20:23], v4 offset:33792
    ds_read_b128 v[24:27], v4 offset:0
    ds_read_b128 v[28:31], v4 offset:1024
    ds_read_b128 v[32:35], v4 offset:28672
    ds_read_b128 v[36:39], v4 offset:29696
    s_waitcnt lgkmcnt(4)
    v_mfma_f32_32x32x16_bf16 v[192:207], v[16:19], v[72:75], v[192:207]
    v_mfma_f32_32x32x16_bf16 v[192:207], v[20:23], v[76:79], v[192:207]
    ds_read_b128 v[40:43], v4 offset:24576
    ds_read_b128 v[44:47], v4 offset:25600
    s_waitcnt lgkmcnt(4)
    v_mfma_f32_32x32x16_bf16 v[96:111], v[24:27], v[72:75], v[96:111]
    v_mfma_f32_32x32x16_bf16 v[96:111], v[28:31], v[76:79], v[96:111]
    ds_read_b128 v[16:19], v4 offset:20480
    ds_read_b128 v[20:23], v4 offset:21504
    s_waitcnt lgkmcnt(4)
    v_mfma_f32_32x32x16_bf16 v[240:255], v[32:35], v[72:75], 0
    v_mfma_f32_32x32x16_bf16 v[240:255], v[36:39], v[76:79], v[240:255]
    ds_read_b128 v[24:27], v4 offset:16384
    ds_read_b128 v[28:31], v4 offset:17408
    s_waitcnt lgkmcnt(4)
    v_mfma_f32_32x32x16_bf16 v[224:239], v[40:43], v[72:75], 0
    s_nop 2
    v_max_f32 v192, v192, v96
    v_max_f32 v193, v193, v97
    v_max_f32 v194, v194, v98
    v_max_f32 v195, v195, v99
    v_max_f32 v196, v196, v100
    v_max_f32 v197, v197, v101
    v_mfma_f32_32x32x16_bf16 v[224:239], v[44:47], v[76:79], v[224:239]
    v_max_f32 v198, v198, v102
    v_max_f32 v199, v199, v103
    v_max_f32 v200, v200, v104
    v_max_f32 v201, v201, v105
    v_max_f32 v202, v202, v106
    v_max_f32 v203, v203, v107
    ds_read_b128 v[32:35], v4 offset:12288
    ds_read_b128 v[36:39], v4 offset:13312
    s_waitcnt lgkmcnt(4)
    v_mfma_f32_32x32x16_bf16 v[176:191], v[16:19], v[72:75], 0
    v_max_f32 v204, v204, v108
    v_max_f32 v205, v205, v109
    v_max_f32 v206, v206, v110
    v_max_f32 v207, v207, v111
    v_max_f32 v92, v192, v193
    v_max_f32 v93, v194, v195
    v_mfma_f32_32x32x16_bf16 v[176:191], v[20:23], v[76:79], v[176:191]
    v_max_f32 v94, v196, v197
    v_max_f32 v95, v198, v199
    v_max3_f32 v92, v92, v200, v201
    v_max3_f32 v93, v93, v202, v203
    v_max3_f32 v94, v94, v204, v205
    v_max3_f32 v95, v95, v206, v207
    ds_read_b128 v[40:43], v4 offset:8192
    ds_read_b128 v[44:47], v4 offset:9216
    s_waitcnt lgkmcnt(4)
    v_mfma_f32_32x32x16_bf16 v[160:175], v[24:27], v[72:75], 0
    v_max3_f32 v92, v92, v240, v241
    v_max3_f32 v93, v93, v242, v243
    v_max3_f32 v94, v94, v244, v245
    v_max3_f32 v95, v95, v246, v247
    v_max3_f32 v92, v92, v248, v249
    v_max3_f32 v93, v93, v250, v251
    v_mfma_f32_32x32x16_bf16 v[160:175], v[28:31], v[76:79], v[160:175]
    v_max3_f32 v94, v94, v252, v253
    v_max3_f32 v95, v95, v254, v255
    v_max3_f32 v92, v92, v224, v225
    v_max3_f32 v93, v93, v226, v227
    v_max3_f32 v94, v94, v228, v229
    v_max3_f32 v95, v95, v230, v231
    ds_read_b128 v[16:19], v4 offset:4096
    ds_read_b128 v[20:23], v4 offset:5120
    s_waitcnt lgkmcnt(4)
    v_mfma_f32_32x32x16_bf16 v[144:159], v[32:35], v[72:75], 0
    v_max3_f32 v92, v92, v232, v233
    v_max3_f32 v93, v93, v234, v235
    v_max3_f32 v94, v94, v236, v237
    v_max3_f32 v95, v95, v238, v239
    v_max3_f32 v92, v92, v176, v177
    v_max3_f32 v93, v93, v178, v179
    v_mfma_f32_32x32x16_bf16 v[144:159], v[36:39], v[76:79], v[144:159]
    v_max3_f32 v94, v94, v180, v181
    v_max3_f32 v95, v95, v182, v183
    v_max3_f32 v92, v92, v184, v185
    v_max3_f32 v93, v93, v186, v187
    v_max3_f32 v94, v94, v188, v189
    v_max3_f32 v95, v95, v190, v191
    s_waitcnt lgkmcnt(2)
    v_mfma_f32_32x32x16_bf16 v[128:143], v[40:43], v[72:75], 0
    v_max3_f32 v92, v92, v160, v161
    v_max3_f32 v93, v93, v162, v163
    v_max3_f32 v94, v94, v164, v165
    v_max3_f32 v95, v95, v166, v167
    v_mfma_f32_32x32x16_bf16 v[128:143], v[44:47], v[76:79], v[128:143]
    v_max3_f32 v92, v92, v168, v169
    v_max3_f32 v93, v93, v170, v171
    v_max3_f32 v94, v94, v172, v173
    v_max3_f32 v95, v95, v174, v175
    s_waitcnt lgkmcnt(0)
    v_mfma_f32_32x32x16_bf16 v[112:127], v[16:19], v[72:75], 0
    v_max3_f32 v92, v92, v144, v145
    v_max3_f32 v93, v93, v146, v147
    v_max3_f32 v94, v94, v148, v149
    v_max3_f32 v95, v95, v150, v151
    v_mfma_f32_32x32x16_bf16 v[112:127], v[20:23], v[76:79], v[112:127]
    v_max3_f32 v92, v92, v152, v153
    v_max3_f32 v93, v93, v154, v155
    v_max3_f32 v94, v94, v156, v157
    v_max3_f32 v95, v95, v158, v159
    v_max3_f32 v92, v92, v128, v129
    v_max3_f32 v93, v93, v130, v131
    v_max3_f32 v94, v94, v132, v133
    v_max3_f32 v95, v95, v134, v135
    v_max3_f32 v92, v92, v136, v137
    v_max3_f32 v93, v93, v138, v139
    v_max3_f32 v94, v94, v140, v141
    v_max3_f32 v95, v95, v142, v143
    v_max3_f32 v92, v92, v112, v113
    v_max3_f32 v93, v93, v114, v115
    v_max3_f32 v94, v94, v116, v117
    v_max3_f32 v95, v95, v118, v119
    v_max3_f32 v92, v92, v120, v121
    v_max3_f32 v93, v93, v122, v123
    v_max3_f32 v94, v94, v124, v125
    v_max3_f32 v95, v95, v126, v127
L_qkdone:
    ds_read_b128 v[16:19], v6 offset:32768
    ds_read_b128 v[20:23], v6 offset:33792
    ds_read_b128 v[24:27], v6 offset:28672
    ds_read_b128 v[28:31], v6 offset:29696
    ds_read_b128 v[32:35], v6 offset:24576
    ds_read_b128 v[36:39], v6 offset:25600
    ds_read_b128 v[40:43], v6 offset:20480
    ds_read_b128 v[44:47], v6 offset:21504
    v_max3_f32 v92, v92, v93, v94
    v_max_f32 v92, v92, v95
    v_mov_b32 v93, v92
    s_nop 1
    v_permlane32_swap_b32 v92, v93
    v_max_f32 v92, v92, v93
    v_sub_f32 v92, 0, v92
    v_cvt_pk_bf16_f32 v93, v92, v92
    v_and_b32 v93, 0xffff0000, v93
    v_sub_f32 v94, v92, v93
    v_cvt_pk_bf16_f32 v93, v92, v94
    v_and_b32 v88, v223, v93
    s_nop 1
    v_mfma_f32_32x32x16_bf16 v[192:207], v[12:15], v[88:91], v[192:207]
    s_cmp_lt_u32 s32, 4
    s_cbranch_scc1 L_noev1
    s_waitcnt vmcnt(0) lgkmcnt(0)
    s_barrier
    s_add_u32 m0, s56, 32768
    s_add_u32 s48, s55, 0
    buffer_load_dwordx4 v219, s[16:19], s48 offen lds
    s_add_u32 m0, s56, 28672
    s_add_u32 s48, s55, 4294901760
    buffer_load_dwordx4 v219, s[16:19], s48 offen lds
    s_add_u32 m0, s56, 40960
    s_add_u32 s48, s55, 131072
    buffer_load_dwordx4 v219, s[16:19], s48 offen lds
    s_add_u32 m0, s56, 36864
    s_add_u32 s48, s55, 65536
    buffer_load_dwordx4 v219, s[16:19], s48 offen lds
    s_add_u32 m0, s56, 49152
    s_add_u32 s48, s55, 262144
    buffer_load_dwordx4 v219, s[16:19], s48 offen lds
    s_add_u32 m0, s56, 45056
    s_add_u32 s48, s55, 196608
    buffer_load_dwordx4 v219, s[16:19], s48 offen lds
    s_add_u32 m0, s56, 57344
    s_add_u32 s48, s55, 393216
    buffer_load_dwordx4 v219, s[16:19], s48 offen lds
    s_add_u32 m0, s56, 53248
    s_add_u32 s48, s55, 327680
    buffer_load_dwordx4 v219, s[16:19], s48 offen lds
    s_add_u32 m0, s56, 65536
    s_add_u32 s48, s55, 524288
    buffer_load_dwordx4 v219, s[16:19], s48 offen lds
    s_add_u32 m0, s56, 61440
    s_add_u32 s48, s55, 458752
    buffer_load_dwordx4 v219, s[16:19], s48 offen lds
    s_add_u32 m0, s56, 73728
    s_add_u32 s48, s55, 655360
    buffer_load_dwordx4 v219, s[16:19], s48 offen lds
    s_add_u32 m0, s56, 69632
    s_add_u32 s48, s55, 589824
    buffer_load_dwordx4 v219, s[16:19], s48 offen lds
    s_add_u32 m0, s56, 81920
    s_add_u32 s48, s55, 786432
    buffer_load_dwordx4 v219, s[16:19], s48 offen lds
    s_add_u32 m0, s56, 77824
    s_add_u32 s48, s55, 720896
    buffer_load_dwordx4 v219, s[16:19], s48 offen lds
    s_add_u32 m0, s56, 90112
    s_add_u32 s48, s55, 917504
    buffer_load_dwordx4 v219, s[16:19], s48 offen lds
    s_add_u32 m0, s56, 86016
    s_add_u32 s48, s55, 851968
    buffer_load_dwordx4 v219, s[16:19], s48 offen lds
    s_add_u32 m0, s56, 98304
    s_add_u32 s48, s55, 1048576
    buffer_load_dwordx4 v219, s[16:19], s48 offen lds
    s_add_u32 m0, s56, 94208
    s_add_u32 s48, s55, 983040
    buffer_load_dwordx4 v219, s[16:19], s48 offen lds
    buffer_store_dwordx4 v[64:67], v217, s[24:27], s0 offen offset:2048 nt sc1
    buffer_store_dwordx4 v[68:71], v217, s[24:27], s0 offen offset:3072 nt sc1
L_noev1:
    v_mfma_f32_32x32x16_bf16 v[240:255], v[12:15], v[88:91], v[240:255]
    s_nop 8
    v_exp_f32 v192, v192
    v_exp_f32 v193, v193
    v_exp_f32 v194, v194
    v_exp_f32 v195, v195
    v_exp_f32 v196, v196
    v_exp_f32 v197, v197
    v_exp_f32 v198, v198
    v_exp_f32 v199, v199
    v_exp_f32 v200, v200
    v_exp_f32 v201, v201
    v_exp_f32 v202, v202
    v_exp_f32 v203, v203
    v_exp_f32 v204, v204
    v_exp_f32 v205, v205
    v_exp_f32 v206, v206
    v_exp_f32 v207, v207
    v_cvt_pk_bf16_f32 v96, v192, v193
    v_cvt_pk_bf16_f32 v97, v194, v195
    v_cvt_pk_bf16_f32 v98, v196, v197
    v_cvt_pk_bf16_f32 v99, v198, v199
    v_cvt_pk_bf16_f32 v100, v200, v201
    v_cvt_pk_bf16_f32 v101, v202, v203
    v_cvt_pk_bf16_f32 v102, v204, v205
    v_cvt_pk_bf16_f32 v103, v206, v207
    v_and_b32 v80, v208, v96
    v_xor_b32 v192, v80, v96
    v_and_b32 v81, v209, v97
    v_xor_b32 v193, v81, v97
    v_and_b32 v82, v210, v98
    v_xor_b32 v194, v82, v98
    v_and_b32 v83, v211, v99
    v_xor_b32 v195, v83, v99
    v_and_b32 v84, v212, v100
    v_xor_b32 v196, v84, v100
    v_and_b32 v85, v213, v101
    v_xor_b32 v197, v85, v101
    v_and_b32 v86, v214, v102
    v_xor_b32 v198, v86, v102
    v_and_b32 v87, v215, v103
    v_xor_b32 v199, v87, v103
    s_cmp_ge_u32 s32, 4
    s_cbranch_scc1 L_noev0
    s_waitcnt lgkmcnt(0)
    s_barrier
    buffer_store_dwordx4 v[64:67], v217, s[24:27], s0 offen offset:2048 nt sc1
    buffer_store_dwordx4 v[68:71], v217, s[24:27], s0 offen offset:3072 nt sc1
L_noev0:
    s_cmp_ge_u32 s32, 6
    s_cbranch_scc1 L_norr
    ds_read_b128 v[40:43], v6 offset:20480
    ds_read_b128 v[44:47], v6 offset:21504
    s_cmp_ge_u32 s32, 4
    s_cbranch_scc1 L_norr
    ds_read_b128 v[32:35], v6 offset:24576
    ds_read_b128 v[36:39], v6 offset:25600
    s_cmp_ge_u32 s32, 2
    s_cbranch_scc1 L_norr
    ds_read_b128 v[24:27], v6 offset:28672
    ds_read_b128 v[28:31], v6 offset:29696
L_norr:
    v_mfma_f32_32x32x16_bf16 v[224:239], v[12:15], v[88:91], v[224:239]
    v_exp_f32 v240, v240
    v_exp_f32 v241, v241
    v_exp_f32 v242, v242
    v_exp_f32 v243, v243
    v_mfma_f32_16x16x32_bf16 v[72:75], v[8:11], v[96:99], 0
    v_exp_f32 v244, v244
    v_exp_f32 v245, v245
    v_exp_f32 v246, v246
    v_exp_f32 v247, v247
    v_mfma_f32_16x16x32_bf16 v[72:75], v[8:11], v[100:103], v[72:75]
    v_exp_f32 v248, v248
    v_exp_f32 v249, v249
    v_exp_f32 v250, v250
    v_exp_f32 v251, v251
    v_mfma_f32_32x32x16_bf16 v[48:63], v[16:19], v[80:83], 0
    v_exp_f32 v252, v252
    v_exp_f32 v253, v253
    v_exp_f32 v254, v254
    v_exp_f32 v255, v255
    v_mfma_f32_32x32x16_bf16 v[48:63], v[20:23], v[84:87], v[48:63]
    ds_read_b128 v[16:19], v6 offset:0
    ds_read_b128 v[20:23], v6 offset:1024
    v_cvt_pk_bf16_f32 v240, v240, v241
    v_cvt_pk_bf16_f32 v241, v242, v243
    v_cvt_pk_bf16_f32 v242, v244, v245
    v_cvt_pk_bf16_f32 v243, v246, v247
    v_cvt_pk_bf16_f32 v244, v248, v249
    v_cvt_pk_bf16_f32 v245, v250, v251
    v_cvt_pk_bf16_f32 v246, v252, v253
    v_cvt_pk_bf16_f32 v247, v254, v255
    v_mfma_f32_32x32x16_bf16 v[176:191], v[12:15], v[88:91], v[176:191]
    v_exp_f32 v224, v224
    v_exp_f32 v225, v225
    v_exp_f32 v226, v226
    v_exp_f32 v227, v227
    v_mfma_f32_16x16x32_bf16 v[72:75], v[8:11], v[240:243], v[72:75]
    v_exp_f32 v228, v228
    v_exp_f32 v229, v229
    v_exp_f32 v230, v230
    v_exp_f32 v231, v231
    v_mfma_f32_16x16x32_bf16 v[72:75], v[8:11], v[244:247], v[72:75]
    v_exp_f32 v232, v232
    v_exp_f32 v233, v233
    v_exp_f32 v234, v234
    v_exp_f32 v235, v235
    s_waitcnt lgkmcnt(2)
    v_mfma_f32_32x32x16_bf16 v[48:63], v[24:27], v[240:243], v[48:63]
    v_exp_f32 v236, v236
    v_exp_f32 v237, v237
    v_exp_f32 v238, v238
    v_exp_f32 v239, v239
    v_mfma_f32_32x32x16_bf16 v[48:63], v[28:31], v[244:247], v[48:63]
    ds_read_b128 v[24:27], v6 offset:16384
    ds_read_b128 v[28:31], v6 offset:17408
    v_cvt_pk_bf16_f32 v224, v224, v225
    v_cvt_pk_bf16_f32 v225, v226, v227
    v_cvt_pk_bf16_f32 v226, v228, v229
    v_cvt_pk_bf16_f32 v227, v230, v231
    v_cvt_pk_bf16_f32 v228, v232, v233
    v_cvt_pk_bf16_f32 v229, v234, v235
    v_cvt_pk_bf16_f32 v230, v236, v237
    v_cvt_pk_bf16_f32 v231, v238, v239
    v_mfma_f32_32x32x16_bf16 v[160:175], v[12:15], v[88:91], v[160:175]
    v_exp_f32 v176, v176
    v_exp_f32 v177, v177
    v_exp_f32 v178, v178
    v_exp_f32 v179, v179
    v_mfma_f32_16x16x32_bf16 v[72:75], v[8:11], v[224:227], v[72:75]
    v_exp_f32 v180, v180
    v_exp_f32 v181, v181
    v_exp_f32 v182, v182
    v_exp_f32 v183, v183
    v_mfma_f32_16x16x32_bf16 v[72:75], v[8:11], v[228:231], v[72:75]
    v_exp_f32 v184, v184
    v_exp_f32 v185, v185
    v_exp_f32 v186, v186
    v_exp_f32 v187, v187
    s_waitcnt lgkmcnt(4)
    v_mfma_f32_32x32x16_bf16 v[48:63], v[32:35], v[224:227], v[48:63]
    v_exp_f32 v188, v188
    v_exp_f32 v189, v189
    v_exp_f32 v190, v190
    v_exp_f32 v191, v191
    v_mfma_f32_32x32x16_bf16 v[48:63], v[36:39], v[228:231], v[48:63]
    ds_read_b128 v[32:35], v6 offset:12288
    ds_read_b128 v[36:39], v6 offset:13312
    v_cvt_pk_bf16_f32 v176, v176, v177
    v_cvt_pk_bf16_f32 v177, v178, v179
    v_cvt_pk_bf16_f32 v178, v180, v181
    v_cvt_pk_bf16_f32 v179, v182, v183
    v_cvt_pk_bf16_f32 v180, v184, v185
    v_cvt_pk_bf16_f32 v181, v186, v187
    v_cvt_pk_bf16_f32 v182, v188, v189
    v_cvt_pk_bf16_f32 v183, v190, v191
    v_mfma_f32_32x32x16_bf16 v[144:159], v[12:15], v[88:91], v[144:159]
    v_exp_f32 v160, v160
    v_exp_f32 v161, v161
    v_exp_f32 v162, v162
    v_mfma_f32_16x16x32_bf16 v[72:75], v[8:11], v[176:179], v[72:75]
    v_exp_f32 v163, v163
    v_exp_f32 v164, v164
    v_exp_f32 v165, v165
    v_mfma_f32_16x16x32_bf16 v[72:75], v[8:11], v[180:183], v[72:75]
    v_exp_f32 v166, v166
    v_exp_f32 v167, v167
    v_exp_f32 v168, v168
    s_waitcnt lgkmcnt(6)
    v_mfma_f32_32x32x16_bf16 v[48:63], v[40:43], v[176:179], v[48:63]
    v_exp_f32 v169, v169
    v_exp_f32 v170, v170
    v_exp_f32 v171, v171
    v_mfma_f32_32x32x16_bf16 v[48:63], v[44:47], v[180:183], v[48:63]
    ds_read_b128 v[40:43], v6 offset:8192
    ds_read_b128 v[44:47], v6 offset:9216
    v_exp_f32 v172, v172
    v_exp_f32 v173, v173
    v_exp_f32 v174, v174
    s_waitcnt lgkmcnt(6)
    v_mfma_f32_32x32x16_bf16 v[48:63], v[16:19], v[192:195], v[48:63]
    v_exp_f32 v175, v175
    v_cvt_pk_bf16_f32 v160, v160, v161
    v_cvt_pk_bf16_f32 v161, v162, v163
    v_cvt_pk_bf16_f32 v162, v164, v165
    v_mfma_f32_32x32x16_bf16 v[48:63], v[20:23], v[196:199], v[48:63]
    ds_read_b128 v[16:19], v6 offset:4096
    ds_read_b128 v[20:23], v6 offset:5120
    v_cvt_pk_bf16_f32 v163, v166, v167
    v_cvt_pk_bf16_f32 v164, v168, v169
    v_cvt_pk_bf16_f32 v165, v170, v171
    v_cvt_pk_bf16_f32 v166, v172, v173
    v_cvt_pk_bf16_f32 v167, v174, v175
    v_mfma_f32_32x32x16_bf16 v[128:143], v[12:15], v[88:91], v[128:143]
    v_exp_f32 v144, v144
    v_exp_f32 v145, v145
    v_exp_f32 v146, v146
    v_exp_f32 v147, v147
    v_mfma_f32_16x16x32_bf16 v[72:75], v[8:11], v[160:163], v[72:75]
    v_exp_f32 v148, v148
    v_exp_f32 v149, v149
    v_exp_f32 v150, v150
    v_exp_f32 v151, v151
    v_mfma_f32_16x16x32_bf16 v[72:75], v[8:11], v[164:167], v[72:75]
    v_exp_f32 v152, v152
    v_exp_f32 v153, v153
    v_exp_f32 v154, v154
    v_exp_f32 v155, v155
    s_waitcnt lgkmcnt(6)
    v_mfma_f32_32x32x16_bf16 v[48:63], v[24:27], v[160:163], v[48:63]
    v_exp_f32 v156, v156
    v_exp_f32 v157, v157
    v_exp_f32 v158, v158
    v_exp_f32 v159, v159
    v_mfma_f32_32x32x16_bf16 v[48:63], v[28:31], v[164:167], v[48:63]
    v_cvt_pk_bf16_f32 v144, v144, v145
    v_cvt_pk_bf16_f32 v145, v146, v147
    v_cvt_pk_bf16_f32 v146, v148, v149
    v_cvt_pk_bf16_f32 v147, v150, v151
    v_cvt_pk_bf16_f32 v148, v152, v153
    v_cvt_pk_bf16_f32 v149, v154, v155
    v_cvt_pk_bf16_f32 v150, v156, v157
    v_cvt_pk_bf16_f32 v151, v158, v159
    v_mfma_f32_32x32x16_bf16 v[112:127], v[12:15], v[88:91], v[112:127]
    v_exp_f32 v128, v128
    v_exp_f32 v129, v129
    v_exp_f32 v130, v130
    v_exp_f32 v131, v131
    v_mfma_f32_16x16x32_bf16 v[72:75], v[8:11], v[144:147], v[72:75]
    v_exp_f32 v132, v132
    v_exp_f32 v133, v133
    v_exp_f32 v134, v134
    v_exp_f32 v135, v135
    v_mfma_f32_16x16x32_bf16 v[72:75], v[8:11], v[148:151], v[72:75]
    v_exp_f32 v136, v136
    v_exp_f32 v137, v137
    v_exp_f32 v138, v138
    v_exp_f32 v139, v139
    s_waitcnt lgkmcnt(4)
    v_mfma_f32_32x32x16_bf16 v[48:63], v[32:35], v[144:147], v[48:63]
    v_exp_f32 v140, v140
    v_exp_f32 v141, v141
    v_exp_f32 v142, v142
    v_exp_f32 v143, v143
    v_mfma_f32_32x32x16_bf16 v[48:63], v[36:39], v[148:151], v[48:63]
    v_cvt_pk_bf16_f32 v128, v128, v129
    v_cvt_pk_bf16_f32 v129, v130, v131
    v_cvt_pk_bf16_f32 v130, v132, v133
    v_cvt_pk_bf16_f32 v131, v134, v135
    v_cvt_pk_bf16_f32 v132, v136, v137
    v_cvt_pk_bf16_f32 v133, v138, v139
    v_cvt_pk_bf16_f32 v134, v140, v141
    v_cvt_pk_bf16_f32 v135, v142, v143
    v_mfma_f32_16x16x32_bf16 v[72:75], v[8:11], v[128:131], v[72:75]
    v_exp_f32 v112, v112
    v_exp_f32 v113, v113
    v_exp_f32 v114, v114
    v_exp_f32 v115, v115
    v_exp_f32 v116, v116
    v_mfma_f32_16x16x32_bf16 v[72:75], v[8:11], v[132:135], v[72:75]
    v_exp_f32 v117, v117
    v_exp_f32 v118, v118
    v_exp_f32 v119, v119
    v_exp_f32 v120, v120
    v_exp_f32 v121, v121
    s_waitcnt lgkmcnt(2)
    v_mfma_f32_32x32x16_bf16 v[48:63], v[40:43], v[128:131], v[48:63]
    v_exp_f32 v122, v122
    v_exp_f32 v123, v123
    v_exp_f32 v124, v124
    v_exp_f32 v125, v125
    v_exp_f32 v126, v126
    v_mfma_f32_32x32x16_bf16 v[48:63], v[44:47], v[132:135], v[48:63]
    v_exp_f32 v127, v127
    v_cvt_pk_bf16_f32 v112, v112, v113
    v_cvt_pk_bf16_f32 v113, v114, v115
    v_cvt_pk_bf16_f32 v114, v116, v117
    v_cvt_pk_bf16_f32 v115, v118, v119
    v_cvt_pk_bf16_f32 v116, v120, v121
    v_cvt_pk_bf16_f32 v117, v122, v123
    v_cvt_pk_bf16_f32 v118, v124, v125
    v_cvt_pk_bf16_f32 v119, v126, v127
    v_mfma_f32_16x16x32_bf16 v[72:75], v[8:11], v[112:115], v[72:75]
    s_nop 0
    v_mfma_f32_16x16x32_bf16 v[72:75], v[8:11], v[116:119], v[72:75]
    s_waitcnt lgkmcnt(0)
    v_mfma_f32_32x32x16_bf16 v[48:63], v[16:19], v[112:115], v[48:63]
    v_mfma_f32_32x32x16_bf16 v[48:63], v[20:23], v[116:119], v[48:63]
    s_nop 4
    v_rcp_f32 v92, v72
    v_rcp_f32 v93, v72
    s_lshl_b32 s36, 1, s3
    v_mov_b32 v8, s36
    s_and_b32 s3, s3, 0xffffff80
    s_nop 1
    v_pk_mul_f32 v[48:49], v[48:49], v[92:93]
    v_pk_mul_f32 v[50:51], v[50:51], v[92:93]
    v_pk_mul_f32 v[52:53], v[52:53], v[92:93]
    v_pk_mul_f32 v[54:55], v[54:55], v[92:93]
    v_pk_mul_f32 v[56:57], v[56:57], v[92:93]
    v_pk_mul_f32 v[58:59], v[58:59], v[92:93]
    v_pk_mul_f32 v[60:61], v[60:61], v[92:93]
    v_pk_mul_f32 v[62:63], v[62:63], v[92:93]
    v_cvt_pk_bf16_f32 v16, v48, v49
    v_cvt_pk_bf16_f32 v17, v50, v51
    v_cvt_pk_bf16_f32 v18, v52, v53
    v_cvt_pk_bf16_f32 v19, v54, v55
    v_cvt_pk_bf16_f32 v20, v56, v57
    v_cvt_pk_bf16_f32 v21, v58, v59
    v_cvt_pk_bf16_f32 v22, v60, v61
    v_cvt_pk_bf16_f32 v23, v62, v63
    buffer_store_dwordx4 v[16:19], v218, s[12:15], s1 offen sc1
    buffer_store_dwordx4 v[20:23], v218, s[12:15], s1 offen offset:512 sc1
    s_lshl_b32 s36, s32, 15
    s_and_b32 s36, s36, 0x10000
    s_add_u32 s36, s36, 32768
    v_add_u32 v4, s36, v220
    v_xor_b32 v5, 32, v4
    v_xor_b32 v6, 64, v4
    v_xor_b32 v7, 0x60, v4
    s_mov_b32 s52, 0
    s_mov_b32 s61, 262144
    s_waitcnt vmcnt(0)
    s_mov_b64 exec, 1
    buffer_atomic_or v8, v2, s[12:15], s3 offen sc1
    s_mov_b64 exec, -1
    s_cmp_lt_u32 s32, 4
    s_cbranch_scc1 L_prA
    s_barrier
    s_branch L_prJ
L_prA:
    s_add_u32 m0, s56, 106496
    s_add_u32 s48, s55, 1179648
    buffer_load_dwordx4 v219, s[16:19], s48 offen lds
    s_add_u32 m0, s56, 110592
    s_add_u32 s48, s55, 1245184
    buffer_load_dwordx4 v219, s[16:19], s48 offen lds
    s_add_u32 m0, s56, 114688
    s_add_u32 s48, s55, 1310720
    buffer_load_dwordx4 v219, s[16:19], s48 offen lds
    s_add_u32 m0, s56, 118784
    s_add_u32 s48, s55, 1376256
    buffer_load_dwordx4 v219, s[16:19], s48 offen lds
    s_add_u32 m0, s56, 122880
    s_add_u32 s48, s55, 1441792
    buffer_load_dwordx4 v219, s[16:19], s48 offen lds
    s_add_u32 m0, s56, 126976
    s_add_u32 s48, s55, 1507328
    buffer_load_dwordx4 v219, s[16:19], s48 offen lds
    s_add_u32 m0, s56, 131072
    s_add_u32 s48, s55, 1572864
    buffer_load_dwordx4 v219, s[16:19], s48 offen lds
    s_add_u32 m0, s56, 135168
    s_add_u32 s48, s55, 1638400
    buffer_load_dwordx4 v219, s[16:19], s48 offen lds
    s_add_u32 m0, s56, 139264
    s_add_u32 s48, s55, 1703936
    buffer_load_dwordx4 v219, s[16:19], s48 offen lds
    s_add_u32 m0, s56, 143360
    s_add_u32 s48, s55, 1769472
    buffer_load_dwordx4 v219, s[16:19], s48 offen lds
    s_add_u32 m0, s56, 147456
    s_add_u32 s48, s55, 1835008
    buffer_load_dwordx4 v219, s[16:19], s48 offen lds
    s_add_u32 m0, s56, 151552
    s_add_u32 s48, s55, 1900544
    buffer_load_dwordx4 v219, s[16:19], s48 offen lds
    s_add_u32 m0, s56, 155648
    s_add_u32 s48, s55, 1966080
    buffer_load_dwordx4 v219, s[16:19], s48 offen lds
    s_add_u32 m0, s56, 159744
    s_add_u32 s48, s55, 2031616
    buffer_load_dwordx4 v219, s[16:19], s48 offen lds
L_prJ:
    s_bitcmp1_b32 s52, 0
    s_cbranch_scc1 L_pk_7
    s_mov_b32 s53, 0
    s_call_b64 s[22:23], L_owait
L_pk_7:
    buffer_load_dwordx4 v[80:83], v2, s[12:15], s58 offen offset:0 sc1
    buffer_load_dwordx4 v[84:87], v2, s[12:15], s59 offen offset:0 sc1
    s_bitcmp1_b32 s52, 1
    s_cbranch_scc1 L_pk_8
    s_mov_b32 s53, 1
    s_call_b64 s[22:23], L_owait
L_pk_8:
    buffer_load_dwordx4 v[88:91], v2, s[12:15], s58 offen offset:1024 sc1
    buffer_load_dwordx4 v[92:95], v2, s[12:15], s59 offen offset:1024 sc1
    s_bitcmp1_b32 s52, 2
    s_cbranch_scc1 L_pk_9
    s_mov_b32 s53, 2
    s_call_b64 s[22:23], L_owait
L_pk_9:
    buffer_load_dwordx4 v[96:99], v2, s[12:15], s58 offen offset:2048 sc1
    buffer_load_dwordx4 v[100:103], v2, s[12:15], s59 offen offset:2048 sc1
    s_bitcmp1_b32 s52, 3
    s_cbranch_scc1 L_pk_10
    s_mov_b32 s53, 3
    s_call_b64 s[22:23], L_owait
L_pk_10:
    buffer_load_dwordx4 v[104:107], v2, s[12:15], s58 offen offset:3072 sc1
    buffer_load_dwordx4 v[108:111], v2, s[12:15], s59 offen offset:3072 sc1
    s_bitcmp1_b32 s52, 4
    s_cbranch_scc1 L_pk_11
    s_mov_b32 s53, 4
    s_call_b64 s[22:23], L_owait
L_pk_11:
    s_add_u32 s58, s58, 4096
    s_add_u32 s59, s59, 4096
    buffer_load_dwordx4 v[112:115], v2, s[12:15], s58 offen offset:0 sc1
    buffer_load_dwordx4 v[116:119], v2, s[12:15], s59 offen offset:0 sc1
    s_bitcmp1_b32 s52, 5
    s_cbranch_scc1 L_pk_12
    s_mov_b32 s53, 5
    s_call_b64 s[22:23], L_owait
L_pk_12:
    buffer_load_dwordx4 v[120:123], v2, s[12:15], s58 offen offset:1024 sc1
    buffer_load_dwordx4 v[124:127], v2, s[12:15], s59 offen offset:1024 sc1
    s_bitcmp1_b32 s52, 6
    s_cbranch_scc1 L_pk_13
    s_mov_b32 s53, 6
    s_call_b64 s[22:23], L_owait
L_pk_13:
    buffer_load_dwordx4 v[128:131], v2, s[12:15], s58 offen offset:2048 sc1
    buffer_load_dwordx4 v[132:135], v2, s[12:15], s59 offen offset:2048 sc1
    s_bitcmp1_b32 s52, 7
    s_cbranch_scc1 L_pk_14
    s_mov_b32 s53, 7
    s_call_b64 s[22:23], L_owait
L_pk_14:
    buffer_load_dwordx4 v[136:139], v2, s[12:15], s58 offen offset:3072 sc1
    buffer_load_dwordx4 v[140:143], v2, s[12:15], s59 offen offset:3072 sc1
    s_cmp_ge_u32 s32, 4
    s_cbranch_scc1 L_prB
    s_waitcnt vmcnt(16)
    s_barrier
L_prB:
    ds_read_b64_tr_b16 v[24:25], v4 offset:0
    ds_read_b64_tr_b16 v[26:27], v4 offset:1024
    ds_read_b64_tr_b16 v[28:29], v5 offset:0
    ds_read_b64_tr_b16 v[30:31], v5 offset:1024
    ds_read_b64_tr_b16 v[32:33], v6 offset:0
    ds_read_b64_tr_b16 v[34:35], v6 offset:1024
    ds_read_b64_tr_b16 v[36:37], v7 offset:0
    ds_read_b64_tr_b16 v[38:39], v7 offset:1024
    ds_read_b64_tr_b16 v[40:41], v4 offset:4096
    ds_read_b64_tr_b16 v[42:43], v4 offset:5120
    ds_read_b64_tr_b16 v[44:45], v5 offset:4096
    ds_read_b64_tr_b16 v[46:47], v5 offset:5120
    ds_read_b64_tr_b16 v[48:49], v6 offset:4096
    ds_read_b64_tr_b16 v[50:51], v6 offset:5120
    ds_read_b64_tr_b16 v[52:53], v7 offset:4096
    ds_read_b64_tr_b16 v[54:55], v7 offset:5120
    s_waitcnt vmcnt(14) lgkmcnt(8)
    v_mfma_f32_16x16x32_bf16 v[224:227], v[24:27], v[80:83], 0
    ds_read_b64_tr_b16 v[56:57], v4 offset:8192
    s_bitcmp1_b32 s52, 8
    v_mfma_f32_16x16x32_bf16 v[240:243], v[24:27], v[84:87], 0
    ds_read_b64_tr_b16 v[58:59], v4 offset:9216
    s_cbranch_scc1 L_pk_15
    s_mov_b32 s53, 8
    s_call_b64 s[22:23], L_owait
L_pk_15:
    v_mfma_f32_16x16x32_bf16 v[228:231], v[28:31], v[80:83], 0
    ds_read_b64_tr_b16 v[60:61], v5 offset:8192
    s_add_u32 s58, s58, 4096
    v_mfma_f32_16x16x32_bf16 v[244:247], v[28:31], v[84:87], 0
    ds_read_b64_tr_b16 v[62:63], v5 offset:9216
    s_add_u32 s59, s59, 4096
    v_mfma_f32_16x16x32_bf16 v[232:235], v[32:35], v[80:83], 0
    ds_read_b64_tr_b16 v[64:65], v6 offset:8192
    buffer_load_dwordx4 v[144:147], v2, s[12:15], s58 offen offset:0 sc1
    v_mfma_f32_16x16x32_bf16 v[248:251], v[32:35], v[84:87], 0
    ds_read_b64_tr_b16 v[66:67], v6 offset:9216
    buffer_load_dwordx4 v[148:151], v2, s[12:15], s59 offen offset:0 sc1
    v_mfma_f32_16x16x32_bf16 v[236:239], v[36:39], v[80:83], 0
    ds_read_b64_tr_b16 v[68:69], v7 offset:8192
    v_mfma_f32_16x16x32_bf16 v[252:255], v[36:39], v[84:87], 0
    ds_read_b64_tr_b16 v[70:71], v7 offset:9216
    s_waitcnt vmcnt(14) lgkmcnt(8)
    v_mfma_f32_16x16x32_bf16 v[224:227], v[40:43], v[88:91], v[224:227]
    ds_read_b64_tr_b16 v[24:25], v4 offset:12288
    s_bitcmp1_b32 s52, 9
    v_mfma_f32_16x16x32_bf16 v[240:243], v[40:43], v[92:95], v[240:243]
    ds_read_b64_tr_b16 v[26:27], v4 offset:13312
    s_cbranch_scc1 L_pk_16
    s_mov_b32 s53, 9
    s_call_b64 s[22:23], L_owait
L_pk_16:
    v_mfma_f32_16x16x32_bf16 v[228:231], v[44:47], v[88:91], v[228:231]
    ds_read_b64_tr_b16 v[28:29], v5 offset:12288
    buffer_load_dwordx4 v[152:155], v2, s[12:15], s58 offen offset:1024 sc1
    v_mfma_f32_16x16x32_bf16 v[244:247], v[44:47], v[92:95], v[244:247]
    ds_read_b64_tr_b16 v[30:31], v5 offset:13312
    buffer_load_dwordx4 v[156:159], v2, s[12:15], s59 offen offset:1024 sc1
    v_mfma_f32_16x16x32_bf16 v[232:235], v[48:51], v[88:91], v[232:235]
    ds_read_b64_tr_b16 v[32:33], v6 offset:12288
    v_mfma_f32_16x16x32_bf16 v[248:251], v[48:51], v[92:95], v[248:251]
    ds_read_b64_tr_b16 v[34:35], v6 offset:13312
    v_mfma_f32_16x16x32_bf16 v[236:239], v[52:55], v[88:91], v[236:239]
    ds_read_b64_tr_b16 v[36:37], v7 offset:12288
    v_mfma_f32_16x16x32_bf16 v[252:255], v[52:55], v[92:95], v[252:255]
    ds_read_b64_tr_b16 v[38:39], v7 offset:13312
    s_waitcnt vmcnt(14) lgkmcnt(8)
    v_mfma_f32_16x16x32_bf16 v[224:227], v[56:59], v[96:99], v[224:227]
    ds_read_b64_tr_b16 v[40:41], v4 offset:16384
    s_bitcmp1_b32 s52, 10
    v_mfma_f32_16x16x32_bf16 v[240:243], v[56:59], v[100:103], v[240:243]
    ds_read_b64_tr_b16 v[42:43], v4 offset:17408
    s_cbranch_scc1 L_pk_17
    s_mov_b32 s53, 10
    s_call_b64 s[22:23], L_owait
L_pk_17:
    v_mfma_f32_16x16x32_bf16 v[228:231], v[60:63], v[96:99], v[228:231]
    ds_read_b64_tr_b16 v[44:45], v5 offset:16384
    buffer_load_dwordx4 v[160:163], v2, s[12:15], s58 offen offset:2048 sc1
    v_mfma_f32_16x16x32_bf16 v[244:247], v[60:63], v[100:103], v[244:247]
    ds_read_b64_tr_b16 v[46:47], v5 offset:17408
    buffer_load_dwordx4 v[164:167], v2, s[12:15], s59 offen offset:2048 sc1
    v_mfma_f32_16x16x32_bf16 v[232:235], v[64:67], v[96:99], v[232:235]
    ds_read_b64_tr_b16 v[48:49], v6 offset:16384
    v_mfma_f32_16x16x32_bf16 v[248:251], v[64:67], v[100:103], v[248:251]
    ds_read_b64_tr_b16 v[50:51], v6 offset:17408
    v_mfma_f32_16x16x32_bf16 v[236:239], v[68:71], v[96:99], v[236:239]
    ds_read_b64_tr_b16 v[52:53], v7 offset:16384
    v_mfma_f32_16x16x32_bf16 v[252:255], v[68:71], v[100:103], v[252:255]
    ds_read_b64_tr_b16 v[54:55], v7 offset:17408
    s_waitcnt vmcnt(14) lgkmcnt(8)
    v_mfma_f32_16x16x32_bf16 v[224:227], v[24:27], v[104:107], v[224:227]
    ds_read_b64_tr_b16 v[56:57], v4 offset:20480
    s_bitcmp1_b32 s52, 11
    v_mfma_f32_16x16x32_bf16 v[240:243], v[24:27], v[108:111], v[240:243]
    ds_read_b64_tr_b16 v[58:59], v4 offset:21504
    s_cbranch_scc1 L_pk_18
    s_mov_b32 s53, 11
    s_call_b64 s[22:23], L_owait
L_pk_18:
    v_mfma_f32_16x16x32_bf16 v[228:231], v[28:31], v[104:107], v[228:231]
    ds_read_b64_tr_b16 v[60:61], v5 offset:20480
    buffer_load_dwordx4 v[168:171], v2, s[12:15], s58 offen offset:3072 sc1
    v_mfma_f32_16x16x32_bf16 v[244:247], v[28:31], v[108:111], v[244:247]
    ds_read_b64_tr_b16 v[62:63], v5 offset:21504
    buffer_load_dwordx4 v[172:175], v2, s[12:15], s59 offen offset:3072 sc1
    v_mfma_f32_16x16x32_bf16 v[232:235], v[32:35], v[104:107], v[232:235]
    ds_read_b64_tr_b16 v[64:65], v6 offset:20480
    v_mfma_f32_16x16x32_bf16 v[248:251], v[32:35], v[108:111], v[248:251]
    ds_read_b64_tr_b16 v[66:67], v6 offset:21504
    v_mfma_f32_16x16x32_bf16 v[236:239], v[36:39], v[104:107], v[236:239]
    ds_read_b64_tr_b16 v[68:69], v7 offset:20480
    v_mfma_f32_16x16x32_bf16 v[252:255], v[36:39], v[108:111], v[252:255]
    ds_read_b64_tr_b16 v[70:71], v7 offset:21504
    s_waitcnt vmcnt(14) lgkmcnt(8)
    v_mfma_f32_16x16x32_bf16 v[224:227], v[40:43], v[112:115], v[224:227]
    ds_read_b64_tr_b16 v[24:25], v4 offset:24576
    s_bitcmp1_b32 s52, 12
    v_mfma_f32_16x16x32_bf16 v[240:243], v[40:43], v[116:119], v[240:243]
    ds_read_b64_tr_b16 v[26:27], v4 offset:25600
    s_cbranch_scc1 L_pk_19
    s_mov_b32 s53, 12
    s_call_b64 s[22:23], L_owait
L_pk_19:
    v_mfma_f32_16x16x32_bf16 v[228:231], v[44:47], v[112:115], v[228:231]
    ds_read_b64_tr_b16 v[28:29], v5 offset:24576
    s_add_u32 s58, s58, 4096
    v_mfma_f32_16x16x32_bf16 v[244:247], v[44:47], v[116:119], v[244:247]
    ds_read_b64_tr_b16 v[30:31], v5 offset:25600
    s_add_u32 s59, s59, 4096
    v_mfma_f32_16x16x32_bf16 v[232:235], v[48:51], v[112:115], v[232:235]
    ds_read_b64_tr_b16 v[32:33], v6 offset:24576
    buffer_load_dwordx4 v[176:179], v2, s[12:15], s58 offen offset:0 sc1
    v_mfma_f32_16x16x32_bf16 v[248:251], v[48:51], v[116:119], v[248:251]
    ds_read_b64_tr_b16 v[34:35], v6 offset:25600
    buffer_load_dwordx4 v[180:183], v2, s[12:15], s59 offen offset:0 sc1
    v_mfma_f32_16x16x32_bf16 v[236:239], v[52:55], v[112:115], v[236:239]
    ds_read_b64_tr_b16 v[36:37], v7 offset:24576
    v_mfma_f32_16x16x32_bf16 v[252:255], v[52:55], v[116:119], v[252:255]
    ds_read_b64_tr_b16 v[38:39], v7 offset:25600
    s_waitcnt vmcnt(14) lgkmcnt(8)
    v_mfma_f32_16x16x32_bf16 v[224:227], v[56:59], v[120:123], v[224:227]
    ds_read_b64_tr_b16 v[40:41], v4 offset:28672
    s_bitcmp1_b32 s52, 13
    v_mfma_f32_16x16x32_bf16 v[240:243], v[56:59], v[124:127], v[240:243]
    ds_read_b64_tr_b16 v[42:43], v4 offset:29696
    s_cbranch_scc1 L_pk_20
    s_mov_b32 s53, 13
    s_call_b64 s[22:23], L_owait
L_pk_20:
    v_mfma_f32_16x16x32_bf16 v[228:231], v[60:63], v[120:123], v[228:231]
    ds_read_b64_tr_b16 v[44:45], v5 offset:28672
    buffer_load_dwordx4 v[184:187], v2, s[12:15], s58 offen offset:1024 sc1
    v_mfma_f32_16x16x32_bf16 v[244:247], v[60:63], v[124:127], v[244:247]
    ds_read_b64_tr_b16 v[46:47], v5 offset:29696
    buffer_load_dwordx4 v[188:191], v2, s[12:15], s59 offen offset:1024 sc1
    v_mfma_f32_16x16x32_bf16 v[232:235], v[64:67], v[120:123], v[232:235]
    ds_read_b64_tr_b16 v[48:49], v6 offset:28672
    v_mfma_f32_16x16x32_bf16 v[248:251], v[64:67], v[124:127], v[248:251]
    ds_read_b64_tr_b16 v[50:51], v6 offset:29696
    v_mfma_f32_16x16x32_bf16 v[236:239], v[68:71], v[120:123], v[236:239]
    ds_read_b64_tr_b16 v[52:53], v7 offset:28672
    v_mfma_f32_16x16x32_bf16 v[252:255], v[68:71], v[124:127], v[252:255]
    ds_read_b64_tr_b16 v[54:55], v7 offset:29696
    s_waitcnt vmcnt(14) lgkmcnt(8)
    v_mfma_f32_16x16x32_bf16 v[224:227], v[24:27], v[128:131], v[224:227]
    ds_read_b64_tr_b16 v[56:57], v4 offset:32768
    s_bitcmp1_b32 s52, 14
    v_mfma_f32_16x16x32_bf16 v[240:243], v[24:27], v[132:135], v[240:243]
    ds_read_b64_tr_b16 v[58:59], v4 offset:33792
    s_cbranch_scc1 L_pk_21
    s_mov_b32 s53, 14
    s_call_b64 s[22:23], L_owait
L_pk_21:
    v_mfma_f32_16x16x32_bf16 v[228:231], v[28:31], v[128:131], v[228:231]
    ds_read_b64_tr_b16 v[60:61], v5 offset:32768
    buffer_load_dwordx4 v[192:195], v2, s[12:15], s58 offen offset:2048 sc1
    v_mfma_f32_16x16x32_bf16 v[244:247], v[28:31], v[132:135], v[244:247]
    ds_read_b64_tr_b16 v[62:63], v5 offset:33792
    buffer_load_dwordx4 v[196:199], v2, s[12:15], s59 offen offset:2048 sc1
    v_mfma_f32_16x16x32_bf16 v[232:235], v[32:35], v[128:131], v[232:235]
    ds_read_b64_tr_b16 v[64:65], v6 offset:32768
    v_mfma_f32_16x16x32_bf16 v[248:251], v[32:35], v[132:135], v[248:251]
    ds_read_b64_tr_b16 v[66:67], v6 offset:33792
    v_mfma_f32_16x16x32_bf16 v[236:239], v[36:39], v[128:131], v[236:239]
    ds_read_b64_tr_b16 v[68:69], v7 offset:32768
    v_mfma_f32_16x16x32_bf16 v[252:255], v[36:39], v[132:135], v[252:255]
    ds_read_b64_tr_b16 v[70:71], v7 offset:33792
    s_waitcnt vmcnt(14) lgkmcnt(8)
    v_mfma_f32_16x16x32_bf16 v[224:227], v[40:43], v[136:139], v[224:227]
    ds_read_b64_tr_b16 v[24:25], v4 offset:36864
    s_bitcmp1_b32 s52, 15
    v_mfma_f32_16x16x32_bf16 v[240:243], v[40:43], v[140:143], v[240:243]
    ds_read_b64_tr_b16 v[26:27], v4 offset:37888
    s_cbranch_scc1 L_pk_22
    s_mov_b32 s53, 15
    s_call_b64 s[22:23], L_owait
L_pk_22:
    v_mfma_f32_16x16x32_bf16 v[228:231], v[44:47], v[136:139], v[228:231]
    ds_read_b64_tr_b16 v[28:29], v5 offset:36864
    buffer_load_dwordx4 v[200:203], v2, s[12:15], s58 offen offset:3072 sc1
    v_mfma_f32_16x16x32_bf16 v[244:247], v[44:47], v[140:143], v[244:247]
    ds_read_b64_tr_b16 v[30:31], v5 offset:37888
    buffer_load_dwordx4 v[204:207], v2, s[12:15], s59 offen offset:3072 sc1
    v_mfma_f32_16x16x32_bf16 v[232:235], v[48:51], v[136:139], v[232:235]
    ds_read_b64_tr_b16 v[32:33], v6 offset:36864
    v_mfma_f32_16x16x32_bf16 v[248:251], v[48:51], v[140:143], v[248:251]
    ds_read_b64_tr_b16 v[34:35], v6 offset:37888
    v_mfma_f32_16x16x32_bf16 v[236:239], v[52:55], v[136:139], v[236:239]
    ds_read_b64_tr_b16 v[36:37], v7 offset:36864
    v_mfma_f32_16x16x32_bf16 v[252:255], v[52:55], v[140:143], v[252:255]
    ds_read_b64_tr_b16 v[38:39], v7 offset:37888
    s_waitcnt vmcnt(14) lgkmcnt(8)
    v_mfma_f32_16x16x32_bf16 v[224:227], v[56:59], v[144:147], v[224:227]
    ds_read_b64_tr_b16 v[40:41], v4 offset:40960
    v_mfma_f32_16x16x32_bf16 v[240:243], v[56:59], v[148:151], v[240:243]
    ds_read_b64_tr_b16 v[42:43], v4 offset:41984
    v_mfma_f32_16x16x32_bf16 v[228:231], v[60:63], v[144:147], v[228:231]
    ds_read_b64_tr_b16 v[44:45], v5 offset:40960
    v_mfma_f32_16x16x32_bf16 v[244:247], v[60:63], v[148:151], v[244:247]
    ds_read_b64_tr_b16 v[46:47], v5 offset:41984
    v_mfma_f32_16x16x32_bf16 v[232:235], v[64:67], v[144:147], v[232:235]
    ds_read_b64_tr_b16 v[48:49], v6 offset:40960
    v_mfma_f32_16x16x32_bf16 v[248:251], v[64:67], v[148:151], v[248:251]
    ds_read_b64_tr_b16 v[50:51], v6 offset:41984
    v_mfma_f32_16x16x32_bf16 v[236:239], v[68:71], v[144:147], v[236:239]
    ds_read_b64_tr_b16 v[52:53], v7 offset:40960
    v_mfma_f32_16x16x32_bf16 v[252:255], v[68:71], v[148:151], v[252:255]
    ds_read_b64_tr_b16 v[54:55], v7 offset:41984
    s_waitcnt vmcnt(12) lgkmcnt(8)
    v_mfma_f32_16x16x32_bf16 v[224:227], v[24:27], v[152:155], v[224:227]
    ds_read_b64_tr_b16 v[56:57], v4 offset:45056
    v_mfma_f32_16x16x32_bf16 v[240:243], v[24:27], v[156:159], v[240:243]
    ds_read_b64_tr_b16 v[58:59], v4 offset:46080
    v_mfma_f32_16x16x32_bf16 v[228:231], v[28:31], v[152:155], v[228:231]
    ds_read_b64_tr_b16 v[60:61], v5 offset:45056
    v_mfma_f32_16x16x32_bf16 v[244:247], v[28:31], v[156:159], v[244:247]
    ds_read_b64_tr_b16 v[62:63], v5 offset:46080
    v_mfma_f32_16x16x32_bf16 v[232:235], v[32:35], v[152:155], v[232:235]
    ds_read_b64_tr_b16 v[64:65], v6 offset:45056
    v_mfma_f32_16x16x32_bf16 v[248:251], v[32:35], v[156:159], v[248:251]
    ds_read_b64_tr_b16 v[66:67], v6 offset:46080
    v_mfma_f32_16x16x32_bf16 v[236:239], v[36:39], v[152:155], v[236:239]
    ds_read_b64_tr_b16 v[68:69], v7 offset:45056
    v_mfma_f32_16x16x32_bf16 v[252:255], v[36:39], v[156:159], v[252:255]
    ds_read_b64_tr_b16 v[70:71], v7 offset:46080
    s_waitcnt vmcnt(10) lgkmcnt(8)
    v_mfma_f32_16x16x32_bf16 v[224:227], v[40:43], v[160:163], v[224:227]
    ds_read_b64_tr_b16 v[24:25], v4 offset:49152
    v_mfma_f32_16x16x32_bf16 v[240:243], v[40:43], v[164:167], v[240:243]
    ds_read_b64_tr_b16 v[26:27], v4 offset:50176
    v_mfma_f32_16x16x32_bf16 v[228:231], v[44:47], v[160:163], v[228:231]
    ds_read_b64_tr_b16 v[28:29], v5 offset:49152
    v_mfma_f32_16x16x32_bf16 v[244:247], v[44:47], v[164:167], v[244:247]
    ds_read_b64_tr_b16 v[30:31], v5 offset:50176
    v_mfma_f32_16x16x32_bf16 v[232:235], v[48:51], v[160:163], v[232:235]
    ds_read_b64_tr_b16 v[32:33], v6 offset:49152
    v_mfma_f32_16x16x32_bf16 v[248:251], v[48:51], v[164:167], v[248:251]
    ds_read_b64_tr_b16 v[34:35], v6 offset:50176
    v_mfma_f32_16x16x32_bf16 v[236:239], v[52:55], v[160:163], v[236:239]
    ds_read_b64_tr_b16 v[36:37], v7 offset:49152
    v_mfma_f32_16x16x32_bf16 v[252:255], v[52:55], v[164:167], v[252:255]
    ds_read_b64_tr_b16 v[38:39], v7 offset:50176
    s_waitcnt vmcnt(8) lgkmcnt(8)
    v_mfma_f32_16x16x32_bf16 v[224:227], v[56:59], v[168:171], v[224:227]
    ds_read_b64_tr_b16 v[40:41], v4 offset:53248
    v_mfma_f32_16x16x32_bf16 v[240:243], v[56:59], v[172:175], v[240:243]
    ds_read_b64_tr_b16 v[42:43], v4 offset:54272
    v_mfma_f32_16x16x32_bf16 v[228:231], v[60:63], v[168:171], v[228:231]
    ds_read_b64_tr_b16 v[44:45], v5 offset:53248
    v_mfma_f32_16x16x32_bf16 v[244:247], v[60:63], v[172:175], v[244:247]
    ds_read_b64_tr_b16 v[46:47], v5 offset:54272
    v_mfma_f32_16x16x32_bf16 v[232:235], v[64:67], v[168:171], v[232:235]
    ds_read_b64_tr_b16 v[48:49], v6 offset:53248
    v_mfma_f32_16x16x32_bf16 v[248:251], v[64:67], v[172:175], v[248:251]
    ds_read_b64_tr_b16 v[50:51], v6 offset:54272
    v_mfma_f32_16x16x32_bf16 v[236:239], v[68:71], v[168:171], v[236:239]
    ds_read_b64_tr_b16 v[52:53], v7 offset:53248
    v_mfma_f32_16x16x32_bf16 v[252:255], v[68:71], v[172:175], v[252:255]
    ds_read_b64_tr_b16 v[54:55], v7 offset:54272
    s_waitcnt vmcnt(6) lgkmcnt(8)
    v_mfma_f32_16x16x32_bf16 v[224:227], v[24:27], v[176:179], v[224:227]
    ds_read_b64_tr_b16 v[56:57], v4 offset:57344
    v_mfma_f32_16x16x32_bf16 v[240:243], v[24:27], v[180:183], v[240:243]
    ds_read_b64_tr_b16 v[58:59], v4 offset:58368
    v_mfma_f32_16x16x32_bf16 v[228:231], v[28:31], v[176:179], v[228:231]
    ds_read_b64_tr_b16 v[60:61], v5 offset:57344
    v_mfma_f32_16x16x32_bf16 v[244:247], v[28:31], v[180:183], v[244:247]
    ds_read_b64_tr_b16 v[62:63], v5 offset:58368
    v_mfma_f32_16x16x32_bf16 v[232:235], v[32:35], v[176:179], v[232:235]
    ds_read_b64_tr_b16 v[64:65], v6 offset:57344
    v_mfma_f32_16x16x32_bf16 v[248:251], v[32:35], v[180:183], v[248:251]
    ds_read_b64_tr_b16 v[66:67], v6 offset:58368
    v_mfma_f32_16x16x32_bf16 v[236:239], v[36:39], v[176:179], v[236:239]
    ds_read_b64_tr_b16 v[68:69], v7 offset:57344
    v_mfma_f32_16x16x32_bf16 v[252:255], v[36:39], v[180:183], v[252:255]
    ds_read_b64_tr_b16 v[70:71], v7 offset:58368
    s_waitcnt vmcnt(4) lgkmcnt(8)
    v_mfma_f32_16x16x32_bf16 v[224:227], v[40:43], v[184:187], v[224:227]
    ds_read_b64_tr_b16 v[24:25], v4 offset:61440
    v_mfma_f32_16x16x32_bf16 v[240:243], v[40:43], v[188:191], v[240:243]
    ds_read_b64_tr_b16 v[26:27], v4 offset:62464
    v_mfma_f32_16x16x32_bf16 v[228:231], v[44:47], v[184:187], v[228:231]
    ds_read_b64_tr_b16 v[28:29], v5 offset:61440
    v_mfma_f32_16x16x32_bf16 v[244:247], v[44:47], v[188:191], v[244:247]
    ds_read_b64_tr_b16 v[30:31], v5 offset:62464
    v_mfma_f32_16x16x32_bf16 v[232:235], v[48:51], v[184:187], v[232:235]
    ds_read_b64_tr_b16 v[32:33], v6 offset:61440
    v_mfma_f32_16x16x32_bf16 v[248:251], v[48:51], v[188:191], v[248:251]
    ds_read_b64_tr_b16 v[34:35], v6 offset:62464
    v_mfma_f32_16x16x32_bf16 v[236:239], v[52:55], v[184:187], v[236:239]
    ds_read_b64_tr_b16 v[36:37], v7 offset:61440
    v_mfma_f32_16x16x32_bf16 v[252:255], v[52:55], v[188:191], v[252:255]
    ds_read_b64_tr_b16 v[38:39], v7 offset:62464
    s_waitcnt vmcnt(2) lgkmcnt(8)
    v_mfma_f32_16x16x32_bf16 v[224:227], v[56:59], v[192:195], v[224:227]
    v_mfma_f32_16x16x32_bf16 v[240:243], v[56:59], v[196:199], v[240:243]
    v_mfma_f32_16x16x32_bf16 v[228:231], v[60:63], v[192:195], v[228:231]
    v_mfma_f32_16x16x32_bf16 v[244:247], v[60:63], v[196:199], v[244:247]
    v_mfma_f32_16x16x32_bf16 v[232:235], v[64:67], v[192:195], v[232:235]
    v_mfma_f32_16x16x32_bf16 v[248:251], v[64:67], v[196:199], v[248:251]
    v_mfma_f32_16x16x32_bf16 v[236:239], v[68:71], v[192:195], v[236:239]
    v_mfma_f32_16x16x32_bf16 v[252:255], v[68:71], v[196:199], v[252:255]
    s_waitcnt vmcnt(0) lgkmcnt(0)
    v_mfma_f32_16x16x32_bf16 v[224:227], v[24:27], v[200:203], v[224:227]
    v_mfma_f32_16x16x32_bf16 v[240:243], v[24:27], v[204:207], v[240:243]
    v_mfma_f32_16x16x32_bf16 v[228:231], v[28:31], v[200:203], v[228:231]
    v_mfma_f32_16x16x32_bf16 v[244:247], v[28:31], v[204:207], v[244:247]
    v_mfma_f32_16x16x32_bf16 v[232:235], v[32:35], v[200:203], v[232:235]
    v_mfma_f32_16x16x32_bf16 v[248:251], v[32:35], v[204:207], v[248:251]
    v_mfma_f32_16x16x32_bf16 v[236:239], v[36:39], v[200:203], v[236:239]
    v_mfma_f32_16x16x32_bf16 v[252:255], v[36:39], v[204:207], v[252:255]
    s_lshl_b32 s36, s32, 12
    v_add_u32 v4, s36, v2
    v_xor_b32 v5, 0x2000, v4
    v_and_b32 v6, 0x7fff, v221
    v_lshrrev_b32 v7, 9, v221
    v_and_b32 v7, 64, v7
    v_add_u32 v6, v6, v7
    v_add_u32 v7, 0x8000, v6
    ds_write_b128 v4, v[240:243] offset:0
    ds_write_b128 v4, v[244:247] offset:1024
    ds_write_b128 v4, v[248:251] offset:2048
    ds_write_b128 v4, v[252:255] offset:3072
    s_waitcnt lgkmcnt(0)
    s_barrier
    ds_read_b128 v[16:19], v5 offset:0
    ds_read_b128 v[20:23], v5 offset:1024
    ds_read_b128 v[24:27], v5 offset:2048
    ds_read_b128 v[28:31], v5 offset:3072
    s_waitcnt lgkmcnt(3)
    v_pk_add_f32 v[224:225], v[224:225], v[16:17]
    v_pk_add_f32 v[226:227], v[226:227], v[18:19]
    v_cvt_pk_bf16_f32 v32, v224, v225
    v_cvt_pk_bf16_f32 v33, v226, v227
    s_waitcnt lgkmcnt(2)
    v_pk_add_f32 v[228:229], v[228:229], v[20:21]
    v_pk_add_f32 v[230:231], v[230:231], v[22:23]
    v_cvt_pk_bf16_f32 v34, v228, v229
    v_cvt_pk_bf16_f32 v35, v230, v231
    s_waitcnt lgkmcnt(1)
    v_pk_add_f32 v[232:233], v[232:233], v[24:25]
    v_pk_add_f32 v[234:235], v[234:235], v[26:27]
    v_cvt_pk_bf16_f32 v36, v232, v233
    v_cvt_pk_bf16_f32 v37, v234, v235
    s_waitcnt lgkmcnt(0)
    v_pk_add_f32 v[236:237], v[236:237], v[28:29]
    v_pk_add_f32 v[238:239], v[238:239], v[30:31]
    v_cvt_pk_bf16_f32 v38, v236, v237
    v_cvt_pk_bf16_f32 v39, v238, v239
    v_permlane16_swap_b32 v32, v34
    v_permlane16_swap_b32 v33, v35
    v_permlane16_swap_b32 v36, v38
    v_permlane16_swap_b32 v37, v39
    v_mov_b32 v40, v32
    v_mov_b32 v41, v33
    v_mov_b32 v42, v34
    v_mov_b32 v43, v35
    s_nop 1
    v_mov_b32_dpp v32, v36 row_ror:8 row_mask:0xf bank_mask:0xc
    v_mov_b32_dpp v33, v37 row_ror:8 row_mask:0xf bank_mask:0xc
    v_mov_b32_dpp v34, v38 row_ror:8 row_mask:0xf bank_mask:0xc
    v_mov_b32_dpp v35, v39 row_ror:8 row_mask:0xf bank_mask:0xc
    v_mov_b32_dpp v36, v40 row_ror:8 row_mask:0xf bank_mask:0x3
    v_mov_b32_dpp v37, v41 row_ror:8 row_mask:0xf bank_mask:0x3
    v_mov_b32_dpp v38, v42 row_ror:8 row_mask:0xf bank_mask:0x3
    v_mov_b32_dpp v39, v43 row_ror:8 row_mask:0xf bank_mask:0x3
    buffer_store_dwordx4 v[32:35], v6, s[24:27], s60 offen nt sc1
    buffer_store_dwordx4 v[36:39], v7, s[24:27], s60 offen nt sc1
L_end:
    s_endpgm
L_owait:
    v_mov_b32 v12, 0
    s_mov_b64 exec, 1
    buffer_atomic_or v12, v2, s[12:15], s57 offen sc0 sc1
    s_mov_b64 exec, -1
    s_waitcnt vmcnt(0)
    v_readfirstlane_b32 s52, v12
    s_sub_u32 s61, s61, 1
    s_bitcmp1_b32 s52, s53
    s_cbranch_scc1 L_owait_done
    s_cmp_gt_i32 s61, 0
    s_cbranch_scc1 L_owait
L_owait_done:
    s_setpc_b64 s[22:23]
L_qkslow:
    ds_read_b128 v[16:19], v4 offset:32768
    ds_read_b128 v[20:23], v4 offset:33792
    s_waitcnt lgkmcnt(0)
    v_mfma_f32_32x32x16_bf16 v[192:207], v[16:19], v[72:75], v[192:207]
    v_mfma_f32_32x32x16_bf16 v[192:207], v[20:23], v[76:79], v[192:207]
    s_cmp_eq_u32 s54, 8
    s_cbranch_scc1 L_fill8
    ds_read_b128 v[16:19], v4 offset:28672
    ds_read_b128 v[20:23], v4 offset:29696
    s_waitcnt lgkmcnt(0)
    v_mfma_f32_32x32x16_bf16 v[240:255], v[16:19], v[72:75], 0
    v_mfma_f32_32x32x16_bf16 v[240:255], v[20:23], v[76:79], v[240:255]
    s_cmp_eq_u32 s54, 7
    s_cbranch_scc1 L_fill7
    ds_read_b128 v[16:19], v4 offset:24576
    ds_read_b128 v[20:23], v4 offset:25600
    s_waitcnt lgkmcnt(0)
    v_mfma_f32_32x32x16_bf16 v[224:239], v[16:19], v[72:75], 0
    v_mfma_f32_32x32x16_bf16 v[224:239], v[20:23], v[76:79], v[224:239]
    s_cmp_eq_u32 s54, 6
    s_cbranch_scc1 L_fill6
    ds_read_b128 v[16:19], v4 offset:20480
    ds_read_b128 v[20:23], v4 offset:21504
    s_waitcnt lgkmcnt(0)
    v_mfma_f32_32x32x16_bf16 v[176:191], v[16:19], v[72:75], 0
    v_mfma_f32_32x32x16_bf16 v[176:191], v[20:23], v[76:79], v[176:191]
    s_cmp_eq_u32 s54, 5
    s_cbranch_scc1 L_fill5
    ds_read_b128 v[16:19], v4 offset:16384
    ds_read_b128 v[20:23], v4 offset:17408
    s_waitcnt lgkmcnt(0)
    v_mfma_f32_32x32x16_bf16 v[160:175], v[16:19], v[72:75], 0
    v_mfma_f32_32x32x16_bf16 v[160:175], v[20:23], v[76:79], v[160:175]
    s_cmp_eq_u32 s54, 4
    s_cbranch_scc1 L_fill4
    ds_read_b128 v[16:19], v4 offset:12288
    ds_read_b128 v[20:23], v4 offset:13312
    s_waitcnt lgkmcnt(0)
    v_mfma_f32_32x32x16_bf16 v[144:159], v[16:19], v[72:75], 0
    v_mfma_f32_32x32x16_bf16 v[144:159], v[20:23], v[76:79], v[144:159]
    s_cmp_eq_u32 s54, 3
    s_cbranch_scc1 L_fill3
    ds_read_b128 v[16:19], v4 offset:8192
    ds_read_b128 v[20:23], v4 offset:9216
    s_waitcnt lgkmcnt(0)
    v_mfma_f32_32x32x16_bf16 v[128:143], v[16:19], v[72:75], 0
    v_mfma_f32_32x32x16_bf16 v[128:143], v[20:23], v[76:79], v[128:143]
    s_cmp_eq_u32 s54, 2
    s_cbranch_scc1 L_fill2
    ds_read_b128 v[16:19], v4 offset:4096
    ds_read_b128 v[20:23], v4 offset:5120
    s_waitcnt lgkmcnt(0)
    v_mfma_f32_32x32x16_bf16 v[112:127], v[16:19], v[72:75], 0
    v_mfma_f32_32x32x16_bf16 v[112:127], v[20:23], v[76:79], v[112:127]
    s_branch L_fill1
L_fill8:
    s_nop 11
    v_pk_mov_b32 v[240:241], s[44:45], s[44:45]
    v_pk_mov_b32 v[242:243], s[44:45], s[44:45]
    v_pk_mov_b32 v[244:245], s[44:45], s[44:45]
    v_pk_mov_b32 v[246:247], s[44:45], s[44:45]
    v_pk_mov_b32 v[248:249], s[44:45], s[44:45]
    v_pk_mov_b32 v[250:251], s[44:45], s[44:45]
    v_pk_mov_b32 v[252:253], s[44:45], s[44:45]
    v_pk_mov_b32 v[254:255], s[44:45], s[44:45]
L_fill7:
    s_nop 11
    v_pk_mov_b32 v[224:225], s[44:45], s[44:45]
    v_pk_mov_b32 v[226:227], s[44:45], s[44:45]
    v_pk_mov_b32 v[228:229], s[44:45], s[44:45]
    v_pk_mov_b32 v[230:231], s[44:45], s[44:45]
    v_pk_mov_b32 v[232:233], s[44:45], s[44:45]
    v_pk_mov_b32 v[234:235], s[44:45], s[44:45]
    v_pk_mov_b32 v[236:237], s[44:45], s[44:45]
    v_pk_mov_b32 v[238:239], s[44:45], s[44:45]
L_fill6:
    s_nop 11
    v_pk_mov_b32 v[176:177], s[44:45], s[44:45]
    v_pk_mov_b32 v[178:179], s[44:45], s[44:45]
    v_pk_mov_b32 v[180:181], s[44:45], s[44:45]
    v_pk_mov_b32 v[182:183], s[44:45], s[44:45]
    v_pk_mov_b32 v[184:185], s[44:45], s[44:45]
    v_pk_mov_b32 v[186:187], s[44:45], s[44:45]
    v_pk_mov_b32 v[188:189], s[44:45], s[44:45]
    v_pk_mov_b32 v[190:191], s[44:45], s[44:45]
L_fill5:
    s_nop 11
    v_pk_mov_b32 v[160:161], s[44:45], s[44:45]
    v_pk_mov_b32 v[162:163], s[44:45], s[44:45]
    v_pk_mov_b32 v[164:165], s[44:45], s[44:45]
    v_pk_mov_b32 v[166:167], s[44:45], s[44:45]
    v_pk_mov_b32 v[168:169], s[44:45], s[44:45]
    v_pk_mov_b32 v[170:171], s[44:45], s[44:45]
    v_pk_mov_b32 v[172:173], s[44:45], s[44:45]
    v_pk_mov_b32 v[174:175], s[44:45], s[44:45]
L_fill4:
    s_nop 11
    v_pk_mov_b32 v[144:145], s[44:45], s[44:45]
    v_pk_mov_b32 v[146:147], s[44:45], s[44:45]
    v_pk_mov_b32 v[148:149], s[44:45], s[44:45]
    v_pk_mov_b32 v[150:151], s[44:45], s[44:45]
    v_pk_mov_b32 v[152:153], s[44:45], s[44:45]
    v_pk_mov_b32 v[154:155], s[44:45], s[44:45]
    v_pk_mov_b32 v[156:157], s[44:45], s[44:45]
    v_pk_mov_b32 v[158:159], s[44:45], s[44:45]
L_fill3:
    s_nop 11
    v_pk_mov_b32 v[128:129], s[44:45], s[44:45]
    v_pk_mov_b32 v[130:131], s[44:45], s[44:45]
    v_pk_mov_b32 v[132:133], s[44:45], s[44:45]
    v_pk_mov_b32 v[134:135], s[44:45], s[44:45]
    v_pk_mov_b32 v[136:137], s[44:45], s[44:45]
    v_pk_mov_b32 v[138:139], s[44:45], s[44:45]
    v_pk_mov_b32 v[140:141], s[44:45], s[44:45]
    v_pk_mov_b32 v[142:143], s[44:45], s[44:45]
L_fill2:
    s_nop 11
    v_pk_mov_b32 v[112:113], s[44:45], s[44:45]
    v_pk_mov_b32 v[114:115], s[44:45], s[44:45]
    v_pk_mov_b32 v[116:117], s[44:45], s[44:45]
    v_pk_mov_b32 v[118:119], s[44:45], s[44:45]
    v_pk_mov_b32 v[120:121], s[44:45], s[44:45]
    v_pk_mov_b32 v[122:123], s[44:45], s[44:45]
    v_pk_mov_b32 v[124:125], s[44:45], s[44:45]
    v_pk_mov_b32 v[126:127], s[44:45], s[44:45]
L_fill1:
    s_nop 7
    s_nop 7
    v_max_f32 v92, v192, v193
    v_max_f32 v93, v194, v195
    v_max_f32 v94, v196, v197
    v_max_f32 v95, v198, v199
    v_max3_f32 v92, v92, v200, v201
    v_max3_f32 v93, v93, v202, v203
    v_max3_f32 v94, v94, v204, v205
    v_max3_f32 v95, v95, v206, v207
    v_max3_f32 v92, v92, v240, v241
    v_max3_f32 v93, v93, v242, v243
    v_max3_f32 v94, v94, v244, v245
    v_max3_f32 v95, v95, v246, v247
    v_max3_f32 v92, v92, v248, v249
    v_max3_f32 v93, v93, v250, v251
    v_max3_f32 v94, v94, v252, v253
    v_max3_f32 v95, v95, v254, v255
    v_max3_f32 v92, v92, v224, v225
    v_max3_f32 v93, v93, v226, v227
    v_max3_f32 v94, v94, v228, v229
    v_max3_f32 v95, v95, v230, v231
    v_max3_f32 v92, v92, v232, v233
    v_max3_f32 v93, v93, v234, v235
    v_max3_f32 v94, v94, v236, v237
    v_max3_f32 v95, v95, v238, v239
    v_max3_f32 v92, v92, v176, v177
    v_max3_f32 v93, v93, v178, v179
    v_max3_f32 v94, v94, v180, v181
    v_max3_f32 v95, v95, v182, v183
    v_max3_f32 v92, v92, v184, v185
    v_max3_f32 v93, v93, v186, v187
    v_max3_f32 v94, v94, v188, v189
    v_max3_f32 v95, v95, v190, v191
    v_max3_f32 v92, v92, v160, v161
    v_max3_f32 v93, v93, v162, v163
    v_max3_f32 v94, v94, v164, v165
    v_max3_f32 v95, v95, v166, v167
    v_max3_f32 v92, v92, v168, v169
    v_max3_f32 v93, v93, v170, v171
    v_max3_f32 v94, v94, v172, v173
    v_max3_f32 v95, v95, v174, v175
    v_max3_f32 v92, v92, v144, v145
    v_max3_f32 v93, v93, v146, v147
    v_max3_f32 v94, v94, v148, v149
    v_max3_f32 v95, v95, v150, v151
    v_max3_f32 v92, v92, v152, v153
    v_max3_f32 v93, v93, v154, v155
    v_max3_f32 v94, v94, v156, v157
    v_max3_f32 v95, v95, v158, v159
    v_max3_f32 v92, v92, v128, v129
    v_max3_f32 v93, v93, v130, v131
    v_max3_f32 v94, v94, v132, v133
    v_max3_f32 v95, v95, v134, v135
    v_max3_f32 v92, v92, v136, v137
    v_max3_f32 v93, v93, v138, v139
    v_max3_f32 v94, v94, v140, v141
    v_max3_f32 v95, v95, v142, v143
    v_max3_f32 v92, v92, v112, v113
    v_max3_f32 v93, v93, v114, v115
    v_max3_f32 v94, v94, v116, v117
    v_max3_f32 v95, v95, v118, v119
    v_max3_f32 v92, v92, v120, v121
    v_max3_f32 v93, v93, v122, v123
    v_max3_f32 v94, v94, v124, v125
    v_max3_f32 v95, v95, v126, v127
    s_branch L_qkdone
L_codeend:
.section .rodata,"a"
.p2align 6
.amdhsa_kernel concat_heads__sliding_block__spectral_fnet__prompt_kernel
  .amdhsa_next_free_vgpr 256
  .amdhsa_next_free_sgpr 102
  .amdhsa_accum_offset 256
  .amdhsa_group_segment_fixed_size 0
  .amdhsa_kernarg_size 88
  .amdhsa_user_sgpr_count 2
  .amdhsa_user_sgpr_kernarg_segment_ptr 1
  .amdhsa_system_sgpr_workgroup_id_x 1
.end_amdhsa_kernel
```
